```python
import torch

def _softmax(x, axis=-1):
    return torch.softmax(x, dim=axis)
def _gelu(x):
    return torch.nn.functional.gelu(x, approximate="tanh")
def _silu(x):
    return torch.nn.functional.silu(x)
def _sigmoid(x):
    return torch.sigmoid(x)
def _layernorm(x, axis=-1, eps=1e-5):
    m = x.mean(dim=axis, keepdim=True)
    v = x.var(dim=axis, keepdim=True, unbiased=False)
    return (x - m) / torch.sqrt(v + eps)
def _scatter_add(tgt, idx, src, axis=0):
    return tgt.clone().index_add_(axis, idx, src)
def _segment_sum(src, seg, n):
    out = torch.zeros((n,) + src.shape[1:], dtype=src.dtype)
    return out.index_add_(0, seg, src)
def _pad(x, pw):
    flat = tuple(v for pair in reversed(pw) for v in pair)
    return torch.nn.functional.pad(x, flat)

kernel_name = 'gated_mix__gqa_block_cached__sliding_block_cached__decode'

def setup_inputs():

    _w = (lambda a: (lambda t: t.to(torch.bfloat16) if t.is_floating_point() else t)(torch.as_tensor(a)))
    def _A_setup():
        B, Sq, D = 2, 1, 512
        Hq, Hkv, Sk, Dh = 32, 32, 4096, 128
        assert Hq % Hkv == 0, (Hq, Hkv)
        return {
            "x": _w((lambda *s: torch.randn(*s, dtype=torch.bfloat16) * 0.05)(B, Sq, D)),
            "k_cache": _w((lambda *s: torch.randn(*s, dtype=torch.bfloat16) * 6.4)(B, Hkv, Sk, Dh)),
            "v_cache": _w((lambda *s: torch.randn(*s, dtype=torch.bfloat16) * 0.05)(B, Hkv, Sk, Dh)),
            "wq": _w((lambda *s: torch.randn(*s, dtype=torch.bfloat16) * 6.4)(D, Hq * Dh) * (D ** -0.5)),
            "wo": _w((lambda *s: torch.randn(*s, dtype=torch.bfloat16) * 0.05)(Hq * Dh, D) * ((Hq * Dh) ** -0.5)),
        }
    _A_in = _A_setup()

    def _B_setup():
        B, Sq, D = 2, 1, 512
        Hq, Hkv, Sk, Dh = 32, 32, 4096, 128
        assert Hq % Hkv == 0, (Hq, Hkv)
        return {
            "x": _w((lambda *s: torch.randn(*s, dtype=torch.bfloat16) * 0.05)(B, Sq, D)),
            "k_cache": _w((lambda *s: torch.randn(*s, dtype=torch.bfloat16) * 6.4)(B, Hkv, Sk, Dh)),
            "v_cache": _w((lambda *s: torch.randn(*s, dtype=torch.bfloat16) * 0.05)(B, Hkv, Sk, Dh)),
            "wq": _w((lambda *s: torch.randn(*s, dtype=torch.bfloat16) * 6.4)(D, Hq * Dh) * (D ** -0.5)),
            "wo": _w((lambda *s: torch.randn(*s, dtype=torch.bfloat16) * 0.05)(Hq * Dh, D) * ((Hq * Dh) ** -0.5)),
        }
    _B_in = _B_setup()

    return {
        "A_x": _A_in["x"],
        "A_k_cache": _A_in["k_cache"],
        "A_v_cache": _A_in["v_cache"],
        "A_wq": _A_in["wq"],
        "A_wo": _A_in["wo"],
        "B_x": _B_in["x"],
        "B_k_cache": _B_in["k_cache"],
        "B_v_cache": _B_in["v_cache"],
        "B_wq": _B_in["wq"],
        "B_wo": _B_in["wo"],
        "gate_w": _w((lambda *s: torch.randn(*s, dtype=torch.bfloat16) * 0.05)(512) * 16.0),
    }

def reference(A_x, A_k_cache, A_v_cache, A_wq, A_wo, B_x, B_k_cache, B_v_cache, B_wq, B_wo, gate_w):
    def _A_ref(x, k_cache, v_cache, wq, wo):
        B, Sq, D = x.shape
        Hq, Dh = 32, 128
        Hkv = k_cache.shape[1]
        rep = Hq // Hkv
        q = (lambda x, *d: x.permute(*d))((x @ wq).reshape(B, Sq, Hq, Dh), 0, 2, 1, 3)
        k = (lambda x, n, axis: torch.repeat_interleave(x, n, dim=axis))(k_cache, rep, axis=1)
        v = (lambda x, n, axis: torch.repeat_interleave(x, n, dim=axis))(v_cache, rep, axis=1)
        scores = torch.einsum("bhqd,bhkd->bhqk", q, k) * (Dh ** -0.5)
        p = _softmax(scores, axis=-1)
        o = torch.einsum("bhqk,bhkd->bhqd", p, v)
        return (lambda x, *d: x.permute(*d))(o, 0, 2, 1, 3).reshape(B, Sq, Hq * Dh) @ wo

    def _B_ref(x, k_cache, v_cache, wq, wo):
        B, Sq, D = x.shape
        Hq, Dh = 32, 128
        Hkv, Sk = k_cache.shape[1], k_cache.shape[2]
        W = min(4096, max(256, Sk // 4))
        rep = Hq // Hkv
        q = (lambda x, *d: x.permute(*d))((x @ wq).reshape(B, Sq, Hq, Dh), 0, 2, 1, 3)
        k = (lambda x, n, axis: torch.repeat_interleave(x, n, dim=axis))(k_cache[:, :, Sk - W:, :], rep, axis=1)
        v = (lambda x, n, axis: torch.repeat_interleave(x, n, dim=axis))(v_cache[:, :, Sk - W:, :], rep, axis=1)
        scores = torch.einsum("bhqd,bhkd->bhqk", q, k) * (Dh ** -0.5)
        p = _softmax(scores, axis=-1)
        o = torch.einsum("bhqk,bhkd->bhqd", p, v)
        return (lambda x, *d: x.permute(*d))(o, 0, 2, 1, 3).reshape(B, Sq, Hq * Dh) @ wo

    x = A_x
    g = _sigmoid((x * gate_w).sum(-1, keepdims=True))
    a = _A_ref(x, A_k_cache, A_v_cache, A_wq, A_wo)
    b = _B_ref(x, B_k_cache, B_v_cache, B_wq, B_wo)
    return g * a + (1 - g) * b
```

```asm
; @launch grid=(256,1,1) block=(512,1,1) lds=24576
.amdgcn_target "amdgcn-amd-amdhsa--gfx950"
.text
.globl gated_mix__gqa_block_cached__sliding_block_cached__decode_kernel
.p2align 8
.type gated_mix__gqa_block_cached__sliding_block_cached__decode_kernel,@function
gated_mix__gqa_block_cached__sliding_block_cached__decode_kernel:
    s_load_dwordx16 s[40:55], s[0:1], 0
    s_load_dwordx8 s[56:63], s[0:1], 64
    s_load_dwordx4 s[64:67], s[0:1], 96
    v_lshrrev_b32 v36, 6, v0
    v_and_b32 v1, 63, v0
    s_cmp_lt_u32 s2, 64
    v_readfirstlane_b32 s76, v36
    s_cbranch_scc0 Lapro
    s_lshr_b32 s78, s2, 3
    s_and_b32 s72, s78, 1
    s_lshl_b32 s79, s78, 2
    s_and_b32 s79, s79, 0x18
    s_add_u32 s87, s2, s78
    s_and_b32 s87, s87, 7
    s_add_u32 s87, s87, s79
    v_lshrrev_b32 v2, 4, v1
    v_and_b32 v3, 15, v1
    s_lshl_b32 s78, s76, 20
    v_lshlrev_b32 v5, 18, v2
    v_lshl_add_u32 v5, v3, 4, v5
    v_add_u32 v5, s78, v5
    s_mov_b32 s15, 0x20000
    s_lshl_b32 s80, s87, 8
    s_sub_u32 s14, 0x400000, s80
    s_and_b32 s70, s2, 7
    s_add_u32 s70, s70, s79
    s_cmp_lt_u32 s76, 4
    s_cbranch_scc0 Lbrest
    s_cmp_eq_u32 s72, 1
    s_waitcnt lgkmcnt(0)
    s_cselect_b64 s[12:13], s[56:57], s[46:47]
    s_add_u32 s12, s12, s80
    s_addc_u32 s13, s13, 0
    buffer_load_dwordx4 v[64:67], v5, s[12:15], 0 offen nt
    s_movk_i32 s86, 0x2000
    buffer_load_dwordx4 v[68:71], v5, s[12:15], s86 offen nt
    s_add_u32 s86, s86, 0x2000
    buffer_load_dwordx4 v[72:75], v5, s[12:15], s86 offen nt
    s_add_u32 s86, s86, 0x2000
    buffer_load_dwordx4 v[76:79], v5, s[12:15], s86 offen nt
    s_add_u32 s86, s86, 0x2000
    buffer_load_dwordx4 v[80:83], v5, s[12:15], s86 offen nt
    s_add_u32 s86, s86, 0x2000
    buffer_load_dwordx4 v[84:87], v5, s[12:15], s86 offen nt
    s_add_u32 s86, s86, 0x2000
    buffer_load_dwordx4 v[88:91], v5, s[12:15], s86 offen nt
    s_add_u32 s86, s86, 0x2000
    buffer_load_dwordx4 v[92:95], v5, s[12:15], s86 offen nt
    s_branch Lbrest
Lapro:
    s_lshr_b32 s78, s2, 3
    s_sub_u32 s78, s78, 8
    s_cmp_ge_u32 s78, 24
    s_cbranch_scc1 Lend
    s_mul_i32 s79, s78, 43
    s_lshr_b32 s79, s79, 7
    s_mul_i32 s80, s79, 3
    s_sub_u32 s73, s78, s80
    s_mul_i32 s79, s79, 36
    s_and_b32 s79, s79, 0x38
    s_and_b32 s74, s2, 7
    s_add_u32 s74, s74, s79
    s_mul_i32 s81, s73, 171
    s_add_u32 s81, s81, 1
    s_lshr_b32 s81, s81, 1
    s_add_u32 s80, s81, s76
    s_mul_i32 s96, s80, 471040
    s_mul_i32 s78, s74, 195584
    s_add_u32 s96, s96, s78
    s_mov_b32 s97, s96
    s_mov_b32 s68, 117760
    s_mov_b32 s69, 3415040
    s_mov_b32 s71, 1047552
    v_lshlrev_b32 v4, 4, v1
    s_mov_b32 s6, 0x100000
    s_mov_b32 s7, 0x20000
    s_lshl_b32 s79, s74, 20
    s_waitcnt lgkmcnt(0)
    s_add_u32 s4, s42, s79
    s_addc_u32 s5, s43, 0
    s_cmp_lt_u32 s76, 4
    s_cbranch_scc1 Lh0
    s_barrier
Lh0:
    s_and_b32 s98, s96, s71
    s_add_u32 s96, s96, s68
    buffer_load_dwordx4 v[80:83], v4, s[4:7], s98 offen nt
    s_and_b32 s98, s96, s71
    s_add_u32 s96, s96, s68
    buffer_load_dwordx4 v[84:87], v4, s[4:7], s98 offen nt
    s_and_b32 s98, s96, s71
    s_add_u32 s96, s96, s68
    buffer_load_dwordx4 v[88:91], v4, s[4:7], s98 offen nt
    s_and_b32 s98, s96, s71
    s_add_u32 s96, s96, s69
    buffer_load_dwordx4 v[92:95], v4, s[4:7], s98 offen nt
    s_and_b32 s98, s96, s71
    s_add_u32 s96, s96, s68
    buffer_load_dwordx4 v[96:99], v4, s[4:7], s98 offen nt
    s_and_b32 s98, s96, s71
    s_add_u32 s96, s96, s68
    buffer_load_dwordx4 v[100:103], v4, s[4:7], s98 offen nt
    s_and_b32 s98, s96, s71
    s_add_u32 s96, s96, s68
    buffer_load_dwordx4 v[104:107], v4, s[4:7], s98 offen nt
    s_and_b32 s98, s96, s71
    s_add_u32 s96, s96, s69
    s_waitcnt vmcnt(6)
    buffer_load_dwordx4 v[108:111], v4, s[4:7], s98 offen nt
    s_add_u32 s8, s44, s79
    s_addc_u32 s9, s45, 0
    s_lshr_b32 s72, s74, 5
    s_and_b32 s70, s74, 31
    s_mov_b32 s10, 0x100000
    s_mov_b32 s11, 0x20000
    s_mov_b32 s92, 0
    s_mov_b32 s3, 0
    s_cmp_eq_u32 s73, 0
    s_addc_u32 s77, 92, 0
    s_sub_u32 s77, s77, s76
    s_lshr_b32 s77, s77, 3
    v_lshrrev_b32 v2, 4, v1
    v_and_b32 v3, 15, v1
    v_lshlrev_b32 v52, 5, v3
    v_lshl_add_u32 v52, v2, 3, v52
    s_mov_b32 s26, 622592
    s_mov_b32 s27, 0x20000
    s_mov_b32 s34, 256
    s_mov_b32 s35, 0x20000
    s_mov_b32 s82, 0x05040100
    s_mov_b32 s83, 0x07060302
    s_mov_b32 s85, 0x3fb8aa3b
    s_lshl_b32 s78, s70, 2
    s_add_u32 s78, s78, s72
    s_lshl_b32 s78, s78, 9
    s_add_u32 s78, s78, 524288
    v_lshl_add_u32 v58, v1, 3, s78
Lcommon2:
    s_getreg_b32 s78, hwreg(HW_REG_XCC_ID, 0, 3)
    s_lshr_b32 s78, 170, s78
    s_bitcmp1_b32 s78, 0
    s_cselect_b64 vcc, -1, 0
    s_mov_b64 s[24:25], s[66:67]
    s_mov_b64 s[32:33], s[64:65]
    s_cmp_eq_u32 s92, 1
    s_cselect_b64 s[16:17], s[58:59], s[48:49]
    s_lshl_b32 s81, s70, 17
    s_add_u32 s16, s16, s81
    s_addc_u32 s17, s17, 0
    s_mov_b32 s18, 0x20000
    s_mov_b32 s19, 0x20000
    v_lshlrev_b32 v6, 11, v2
    v_lshl_add_u32 v6, v3, 3, v6
    s_lshl_b32 s86, s76, 7
    s_or_b32 s78, s76, s92
    s_cbranch_scc1 Lnosnap
    buffer_load_dwordx2 v[60:61], v58, s[24:27], 0 offen sc1
Lnosnap:
    s_lshl_b32 s87, s74, 2
    s_add_u32 s87, s87, s73
    s_lshl_b32 s78, s87, 11
    s_lshl_b32 s80, s76, 8
    s_add_u32 s78, s78, s80
    v_lshl_add_u32 v7, v3, 2, s78
    v_lshl_add_u32 v7, v2, 6, v7
    s_and_b32 s98, s96, s71
    s_add_u32 s96, s96, s68
    s_cbranch_vccnz Lw1
    s_waitcnt vmcnt(6)
Lw1:
    buffer_load_dwordx4 v[112:115], v4, s[4:7], s98 offen nt
    s_and_b32 s98, s96, s71
    s_add_u32 s96, s96, s68
    s_cbranch_vccnz Lw2
    s_waitcnt vmcnt(6)
Lw2:
    buffer_load_dwordx4 v[116:119], v4, s[4:7], s98 offen nt
    s_and_b32 s98, s96, s71
    s_add_u32 s96, s96, s68
    s_cbranch_vccnz Lw3
    s_waitcnt vmcnt(6)
Lw3:
    buffer_load_dwordx4 v[120:123], v4, s[4:7], s98 offen nt
    s_and_b32 s98, s96, s71
    s_add_u32 s96, s96, s69
    s_cbranch_vccnz Lw4
    s_waitcnt vmcnt(6)
Lw4:
    buffer_load_dwordx4 v[124:127], v4, s[4:7], s98 offen nt
    s_and_b32 s98, s96, s71
    s_add_u32 s96, s96, s68
    s_cbranch_vccnz Lw5
    s_waitcnt vmcnt(6)
Lw5:
    buffer_load_dwordx4 v[128:131], v4, s[4:7], s98 offen nt
    s_and_b32 s98, s96, s71
    s_add_u32 s96, s96, s68
    s_cbranch_vccnz Lw6
    s_waitcnt vmcnt(6)
Lw6:
    buffer_load_dwordx4 v[132:135], v4, s[4:7], s98 offen nt
    s_and_b32 s98, s96, s71
    s_add_u32 s96, s96, s68
    s_cbranch_vccnz Lw7
    s_waitcnt vmcnt(6)
Lw7:
    buffer_load_dwordx4 v[136:139], v4, s[4:7], s98 offen nt
    s_and_b32 s98, s96, s71
    s_add_u32 s96, s96, s69
    s_waitcnt vmcnt(14)
    s_cbranch_vccnz Lw8
    s_waitcnt vmcnt(6)
Lw8:
    buffer_load_dwordx4 v[140:143], v4, s[4:7], s98 offen nt
    buffer_load_dwordx2 v[64:65], v6, s[16:19], s86 offen offset:0
    buffer_load_dwordx2 v[66:67], v6, s[16:19], s86 offen offset:1024
    s_and_b32 s98, s96, s71
    s_add_u32 s96, s96, s68
    s_waitcnt vmcnt(14)
    s_cbranch_vccnz Lw9
    s_waitcnt vmcnt(6)
Lw9:
    buffer_load_dwordx4 v[144:147], v4, s[4:7], s98 offen nt
    s_and_b32 s98, s96, s71
    s_add_u32 s96, s96, s68
    s_waitcnt vmcnt(14)
    s_cbranch_vccnz Lw10
    s_waitcnt vmcnt(6)
Lw10:
    buffer_load_dwordx4 v[148:151], v4, s[4:7], s98 offen nt
    s_and_b32 s98, s96, s71
    s_add_u32 s96, s96, s68
    s_waitcnt vmcnt(14)
    s_cbranch_vccnz Lw11
    s_waitcnt vmcnt(6)
Lw11:
    buffer_load_dwordx4 v[152:155], v4, s[4:7], s98 offen nt
    s_and_b32 s98, s96, s71
    s_add_u32 s96, s96, s69
    s_waitcnt vmcnt(14)
    s_cbranch_vccnz Lw12
    s_waitcnt vmcnt(6)
Lw12:
    buffer_load_dwordx4 v[156:159], v4, s[4:7], s98 offen nt
    buffer_load_dword v0, v7, s[24:27], 0 offen sc1
    s_and_b32 s98, s96, s71
    s_add_u32 s96, s96, s68
    s_waitcnt vmcnt(14)
    s_cbranch_vccnz Lw13
    s_waitcnt vmcnt(6)
Lw13:
    buffer_load_dwordx4 v[160:163], v4, s[4:7], s98 offen nt
    s_and_b32 s98, s96, s71
    s_add_u32 s96, s96, s68
    s_waitcnt vmcnt(14)
    s_cbranch_vccnz Lw14
    s_waitcnt vmcnt(6)
Lw14:
    buffer_load_dwordx4 v[164:167], v4, s[4:7], s98 offen nt
    s_and_b32 s98, s96, s71
    s_add_u32 s96, s96, s68
    s_waitcnt vmcnt(14)
    s_cbranch_vccnz Lw15
    s_waitcnt vmcnt(6)
Lw15:
    buffer_load_dwordx4 v[168:171], v4, s[4:7], s98 offen nt
    s_and_b32 s98, s96, s71
    s_add_u32 s96, s96, s69
    s_waitcnt vmcnt(14)
    s_cbranch_vccnz Lw16
    s_waitcnt vmcnt(6)
Lw16:
    buffer_load_dwordx4 v[172:175], v4, s[4:7], s98 offen nt
    s_add_u32 s86, s86, 0x2000
    buffer_load_dwordx2 v[68:69], v6, s[16:19], s86 offen offset:0
    buffer_load_dwordx2 v[70:71], v6, s[16:19], s86 offen offset:1024
    s_and_b32 s98, s96, s71
    s_add_u32 s96, s96, s68
    s_waitcnt vmcnt(14)
    s_cbranch_vccnz Lw17
    s_waitcnt vmcnt(6)
Lw17:
    buffer_load_dwordx4 v[176:179], v4, s[4:7], s98 offen nt
    s_and_b32 s98, s96, s71
    s_add_u32 s96, s96, s68
    s_waitcnt vmcnt(14)
    s_cbranch_vccnz Lw18
    s_waitcnt vmcnt(6)
Lw18:
    buffer_load_dwordx4 v[180:183], v4, s[4:7], s98 offen nt
    s_and_b32 s98, s96, s71
    s_add_u32 s96, s96, s68
    s_waitcnt vmcnt(14)
    s_cbranch_vccnz Lw19
    s_waitcnt vmcnt(6)
Lw19:
    buffer_load_dwordx4 v[184:187], v4, s[4:7], s98 offen nt
    s_and_b32 s98, s96, s71
    s_add_u32 s96, s96, s69
    s_waitcnt vmcnt(14)
    s_cbranch_vccnz Lw20
    s_waitcnt vmcnt(6)
Lw20:
    buffer_load_dwordx4 v[188:191], v4, s[4:7], s98 offen nt
    s_add_u32 s86, s86, 0x2000
    buffer_load_dwordx2 v[72:73], v6, s[16:19], s86 offen offset:0
    buffer_load_dwordx2 v[74:75], v6, s[16:19], s86 offen offset:1024
    s_and_b32 s98, s96, s71
    s_add_u32 s96, s96, s68
    s_waitcnt vmcnt(14)
    s_cbranch_vccnz Lw21
    s_waitcnt vmcnt(6)
Lw21:
    buffer_load_dwordx4 v[192:195], v4, s[4:7], s98 offen nt
    s_and_b32 s98, s96, s71
    s_add_u32 s96, s96, s68
    s_waitcnt vmcnt(14)
    s_cbranch_vccnz Lw22
    s_waitcnt vmcnt(6)
Lw22:
    buffer_load_dwordx4 v[196:199], v4, s[4:7], s98 offen nt
    s_and_b32 s98, s96, s71
    s_add_u32 s96, s96, s68
    s_waitcnt vmcnt(14)
    s_cbranch_vccnz Lw23
    s_waitcnt vmcnt(6)
Lw23:
    buffer_load_dwordx4 v[200:203], v4, s[4:7], s98 offen nt
    s_and_b32 s98, s96, s71
    s_add_u32 s96, s96, s69
    s_waitcnt vmcnt(14)
    s_cbranch_vccnz Lw24
    s_waitcnt vmcnt(6)
Lw24:
    buffer_load_dwordx4 v[204:207], v4, s[4:7], s98 offen nt
    s_cmp_le_u32 s77, 8
    s_cbranch_scc1 Lw25
    s_and_b32 s98, s96, s71
    s_add_u32 s96, s96, s68
    s_waitcnt vmcnt(14)
    s_cbranch_vccnz Lw26
    s_waitcnt vmcnt(6)
Lw26:
    buffer_load_dwordx4 v[208:211], v4, s[4:7], s98 offen nt
    s_and_b32 s98, s96, s71
    s_add_u32 s96, s96, s68
    s_waitcnt vmcnt(14)
    s_cbranch_vccnz Lw27
    s_waitcnt vmcnt(6)
Lw27:
    buffer_load_dwordx4 v[212:215], v4, s[4:7], s98 offen nt
    s_and_b32 s98, s96, s71
    s_add_u32 s96, s96, s68
    s_waitcnt vmcnt(14)
    s_cbranch_vccnz Lw28
    s_waitcnt vmcnt(6)
Lw28:
    buffer_load_dwordx4 v[216:219], v4, s[4:7], s98 offen nt
    s_and_b32 s98, s96, s71
    s_add_u32 s96, s96, s69
    s_waitcnt vmcnt(14)
    s_cbranch_vccnz Lw29
    s_waitcnt vmcnt(6)
Lw29:
    buffer_load_dwordx4 v[220:223], v4, s[4:7], s98 offen nt
Lw25:
    s_add_u32 s86, s86, 0x2000
    buffer_load_dwordx2 v[76:77], v6, s[16:19], s86 offen offset:0
    buffer_load_dwordx2 v[78:79], v6, s[16:19], s86 offen offset:1024
    s_cmp_le_u32 s77, 9
    s_cbranch_scc1 Lw30
    s_and_b32 s98, s96, s71
    s_add_u32 s96, s96, s68
    s_waitcnt vmcnt(14)
    s_cbranch_vccnz Lw31
    s_waitcnt vmcnt(6)
Lw31:
    buffer_load_dwordx4 v[224:227], v4, s[4:7], s98 offen nt
    s_and_b32 s98, s96, s71
    s_add_u32 s96, s96, s68
    s_waitcnt vmcnt(14)
    s_cbranch_vccnz Lw32
    s_waitcnt vmcnt(6)
Lw32:
    buffer_load_dwordx4 v[228:231], v4, s[4:7], s98 offen nt
    s_and_b32 s98, s96, s71
    s_add_u32 s96, s96, s68
    s_waitcnt vmcnt(14)
    s_cbranch_vccnz Lw33
    s_waitcnt vmcnt(6)
Lw33:
    buffer_load_dwordx4 v[232:235], v4, s[4:7], s98 offen nt
    s_and_b32 s98, s96, s71
    s_add_u32 s96, s96, s69
    s_waitcnt vmcnt(14)
    s_cbranch_vccnz Lw34
    s_waitcnt vmcnt(6)
Lw34:
    buffer_load_dwordx4 v[236:239], v4, s[4:7], s98 offen nt
Lw30:
    s_cmp_le_u32 s77, 10
    s_cbranch_scc1 Lw35
    s_and_b32 s98, s96, s71
    s_add_u32 s96, s96, s68
    s_waitcnt vmcnt(14)
    s_cbranch_vccnz Lw36
    s_waitcnt vmcnt(6)
Lw36:
    buffer_load_dwordx4 v[240:243], v4, s[4:7], s98 offen nt
    s_and_b32 s98, s96, s71
    s_add_u32 s96, s96, s68
    s_waitcnt vmcnt(14)
    s_cbranch_vccnz Lw37
    s_waitcnt vmcnt(6)
Lw37:
    buffer_load_dwordx4 v[244:247], v4, s[4:7], s98 offen nt
    s_and_b32 s98, s96, s71
    s_add_u32 s96, s96, s68
    s_waitcnt vmcnt(14)
    s_cbranch_vccnz Lw38
    s_waitcnt vmcnt(6)
Lw38:
    buffer_load_dwordx4 v[248:251], v4, s[4:7], s98 offen nt
    s_and_b32 s98, s96, s71
    s_add_u32 s96, s96, s69
    s_waitcnt vmcnt(14)
    s_cbranch_vccnz Lw39
    s_waitcnt vmcnt(6)
Lw39:
    buffer_load_dwordx4 v[252:255], v4, s[4:7], s98 offen nt
Lw35:
    s_lshr_b32 s78, s76, 2
    s_or_b32 s78, s78, s92
    s_cbranch_scc1 Lh1
    s_barrier
Lh1:
    s_mov_b32 s20, 286331153
    s_mov_b32 s21, s20
    s_mov_b32 s22, 572662306
    s_mov_b32 s23, s22
    s_mov_b32 s36, 1145324612
    s_mov_b32 s37, s36
    s_mov_b32 s38, 2290649224
    s_mov_b32 s39, s38
    v_mov_b32 v28, 0xff800000
    v_mov_b32 v29, 0xff800000
    v_mov_b32 v30, 0xff800000
    s_mov_b64 s[28:29], s[62:63]
    s_mov_b32 s30, 2048
    s_mov_b32 s31, 0x20000
    s_mov_b32 s84, 0x3db504f3
    s_lshl_b32 s78, s76, 9
    v_lshl_add_u32 v53, v1, 3, s78
    v_lshlrev_b32 v57, 1, v3
    v_and_b32 v59, 7, v1
    v_lshlrev_b32 v59, 3, v59
    s_cmp_lg_u32 s76, 0
    s_cbranch_scc1 Lqbar
Lqpoll:
    s_mov_b32 s81, 0
Lq0:
    buffer_load_dwordx2 v[36:37], v58, s[24:27], 0 offen sc1
    s_waitcnt vmcnt(0)
    v_bitop3_b32 v38, v36, v60, 1 bitop3:0x28
    v_bitop3_b32 v38, v37, v61, v38 bitop3:0x28
    v_cmp_eq_u32 vcc, 0, v38
    s_cbranch_vccz Lq1
    s_add_u32 s81, s81, 1
    s_and_b32 s78, s81, 15
    s_cbranch_scc1 Lq0
    v_mov_b32 v38, 0
    s_mov_b64 exec, 1
    buffer_load_dword v39, v38, s[32:35], 0 offen sc1
    s_waitcnt vmcnt(0)
    v_readfirstlane_b32 s78, v39
    s_mov_b64 exec, -1
    s_cmp_gt_u32 s81, 0x40000
    s_cbranch_scc1 Lq1
    s_cmp_eq_u32 s78, 0
    s_cbranch_scc1 Lq0
    v_bfe_u32 v38, v36, 1, 15
    v_bfe_u32 v39, v37, 1, 15
    v_lshl_or_b32 v38, v39, 15, v38
    v_cmp_ne_u32 vcc, s78, v38
    s_cbranch_vccnz Lq0
Lq1:
    v_bfe_u32 v38, v36, 1, 15
    v_bfe_u32 v39, v37, 1, 15
    v_perm_b32 v36, v37, v36, s83
    v_lshrrev_b32 v37, 1, v52
    v_lshl_or_b32 v38, v39, 15, v38
    ds_write_b32 v37, v36 offset:14592
    ds_write_b32 v37, v38 offset:14848
    s_waitcnt lgkmcnt(0)
Lqbar:
    v_lshlrev_b32 v37, 4, v3
    s_barrier
    ds_read_b128 v[8:11], v37 offset:14592
    ds_read_b32 v55, v37 offset:14848
    v_lshlrev_b32 v52, 3, v1
    s_waitcnt lgkmcnt(0)
    s_waitcnt vmcnt(37)
    s_cmp_gt_u32 s77, 10
    s_cbranch_scc1 Lw40
    s_waitcnt vmcnt(33)
    s_cmp_gt_u32 s77, 8
    s_cbranch_scc1 Lw40
    s_waitcnt vmcnt(25)
Lw40:
    v_dot2_f32_bf16 v12, v128, v8, 0
    v_dot2_f32_bf16 v13, v132, v8, 0
    v_dot2_f32_bf16 v14, v136, v8, 0
    v_dot2_f32_bf16 v15, v140, v8, 0
    v_dot2c_f32_bf16 v12, v129, v9
    v_dot2c_f32_bf16 v13, v133, v9
    v_dot2c_f32_bf16 v14, v137, v9
    v_dot2c_f32_bf16 v15, v141, v9
    v_dot2c_f32_bf16 v12, v130, v10
    v_dot2c_f32_bf16 v13, v134, v10
    v_dot2c_f32_bf16 v14, v138, v10
    v_dot2c_f32_bf16 v15, v142, v10
    v_dot2c_f32_bf16 v12, v131, v11
    v_dot2c_f32_bf16 v13, v135, v11
    v_dot2c_f32_bf16 v14, v139, v11
    v_dot2c_f32_bf16 v15, v143, v11
    v_dot2_f32_bf16 v16, v80, v8, 0
    v_dot2_f32_bf16 v17, v84, v8, 0
    v_dot2_f32_bf16 v18, v88, v8, 0
    v_dot2_f32_bf16 v19, v92, v8, 0
    v_dot2c_f32_bf16 v16, v81, v9
    v_dot2c_f32_bf16 v17, v85, v9
    v_dot2c_f32_bf16 v18, v89, v9
    v_dot2c_f32_bf16 v19, v93, v9
    v_dot2c_f32_bf16 v16, v82, v10
    v_dot2c_f32_bf16 v17, v86, v10
    v_dot2c_f32_bf16 v18, v90, v10
    v_dot2c_f32_bf16 v19, v94, v10
    v_dot2c_f32_bf16 v16, v83, v11
    v_dot2c_f32_bf16 v17, v87, v11
    v_dot2c_f32_bf16 v18, v91, v11
    v_dot2c_f32_bf16 v19, v95, v11
    v_add_f32_dpp v36, v12, v12 row_ror:8 row_mask:0xf bank_mask:0x3
    v_add_f32_dpp v37, v13, v13 row_ror:8 row_mask:0xf bank_mask:0x3
    v_add_f32_dpp v38, v16, v16 row_ror:8 row_mask:0xf bank_mask:0x3
    v_add_f32_dpp v39, v17, v17 row_ror:8 row_mask:0xf bank_mask:0x3
    v_add_f32_dpp v36, v14, v14 row_ror:8 row_mask:0xf bank_mask:0xc
    v_add_f32_dpp v37, v15, v15 row_ror:8 row_mask:0xf bank_mask:0xc
    v_add_f32_dpp v38, v18, v18 row_ror:8 row_mask:0xf bank_mask:0xc
    v_add_f32_dpp v39, v19, v19 row_ror:8 row_mask:0xf bank_mask:0xc
    v_add_f32_dpp v36, v36, v36 row_half_mirror row_mask:0xf bank_mask:0x5
    v_add_f32_dpp v38, v38, v38 row_half_mirror row_mask:0xf bank_mask:0x5
    s_nop 0
    v_add_f32_dpp v36, v37, v37 row_half_mirror row_mask:0xf bank_mask:0xa
    v_add_f32_dpp v38, v39, v39 row_half_mirror row_mask:0xf bank_mask:0xa
    s_nop 0
    v_add_f32_dpp v36, v36, v36 quad_perm:[1,0,3,2] row_mask:0xf bank_mask:0xf
    v_add_f32_dpp v38, v38, v38 quad_perm:[1,0,3,2] row_mask:0xf bank_mask:0xf
    s_nop 0
    v_add_f32_dpp v36, v36, v36 quad_perm:[2,3,0,1] row_mask:0xf bank_mask:0xf
    v_add_f32_dpp v38, v38, v38 quad_perm:[2,3,0,1] row_mask:0xf bank_mask:0xf
    v_cndmask_b32 v28, v28, v36, s[38:39]
    v_cndmask_b32 v28, v28, v38, s[20:21]
    s_add_u32 s86, s86, 0x2000
    buffer_load_dwordx2 v[80:81], v6, s[16:19], s86 offen offset:0
    buffer_load_dwordx2 v[82:83], v6, s[16:19], s86 offen offset:1024
    s_add_u32 s86, s86, 0x2000
    buffer_load_dwordx2 v[84:85], v6, s[16:19], s86 offen offset:0
    buffer_load_dwordx2 v[86:87], v6, s[16:19], s86 offen offset:1024
    s_and_b32 s98, s97, s71
    s_add_u32 s97, s97, s68
    buffer_load_dwordx4 v[128:131], v4, s[8:11], s98 offen nt
    s_and_b32 s98, s97, s71
    s_add_u32 s97, s97, s68
    buffer_load_dwordx4 v[132:135], v4, s[8:11], s98 offen nt
    s_and_b32 s98, s97, s71
    s_add_u32 s97, s97, s68
    buffer_load_dwordx4 v[136:139], v4, s[8:11], s98 offen nt
    s_and_b32 s98, s97, s71
    s_add_u32 s97, s97, s69
    buffer_load_dwordx4 v[140:143], v4, s[8:11], s98 offen nt
    s_waitcnt vmcnt(49)
    s_cmp_gt_u32 s77, 10
    s_cbranch_scc1 Lw41
    s_waitcnt vmcnt(45)
    s_cmp_gt_u32 s77, 8
    s_cbranch_scc1 Lw41
    s_waitcnt vmcnt(37)
Lw41:
    v_dot2_f32_bf16 v12, v96, v8, 0
    v_dot2_f32_bf16 v13, v100, v8, 0
    v_dot2_f32_bf16 v14, v104, v8, 0
    v_dot2_f32_bf16 v15, v108, v8, 0
    v_dot2c_f32_bf16 v12, v97, v9
    v_dot2c_f32_bf16 v13, v101, v9
    v_dot2c_f32_bf16 v14, v105, v9
    v_dot2c_f32_bf16 v15, v109, v9
    v_dot2c_f32_bf16 v12, v98, v10
    v_dot2c_f32_bf16 v13, v102, v10
    v_dot2c_f32_bf16 v14, v106, v10
    v_dot2c_f32_bf16 v15, v110, v10
    v_dot2c_f32_bf16 v12, v99, v11
    v_dot2c_f32_bf16 v13, v103, v11
    v_dot2c_f32_bf16 v14, v107, v11
    v_dot2c_f32_bf16 v15, v111, v11
    v_dot2_f32_bf16 v16, v112, v8, 0
    v_dot2_f32_bf16 v17, v116, v8, 0
    v_dot2_f32_bf16 v18, v120, v8, 0
    v_dot2_f32_bf16 v19, v124, v8, 0
    v_dot2c_f32_bf16 v16, v113, v9
    v_dot2c_f32_bf16 v17, v117, v9
    v_dot2c_f32_bf16 v18, v121, v9
    v_dot2c_f32_bf16 v19, v125, v9
    v_dot2c_f32_bf16 v16, v114, v10
    v_dot2c_f32_bf16 v17, v118, v10
    v_dot2c_f32_bf16 v18, v122, v10
    v_dot2c_f32_bf16 v19, v126, v10
    v_dot2c_f32_bf16 v16, v115, v11
    v_dot2c_f32_bf16 v17, v119, v11
    v_dot2c_f32_bf16 v18, v123, v11
    v_dot2c_f32_bf16 v19, v127, v11
    v_add_f32_dpp v36, v12, v12 row_ror:8 row_mask:0xf bank_mask:0x3
    v_add_f32_dpp v37, v13, v13 row_ror:8 row_mask:0xf bank_mask:0x3
    v_add_f32_dpp v38, v16, v16 row_ror:8 row_mask:0xf bank_mask:0x3
    v_add_f32_dpp v39, v17, v17 row_ror:8 row_mask:0xf bank_mask:0x3
    v_add_f32_dpp v36, v14, v14 row_ror:8 row_mask:0xf bank_mask:0xc
    v_add_f32_dpp v37, v15, v15 row_ror:8 row_mask:0xf bank_mask:0xc
    v_add_f32_dpp v38, v18, v18 row_ror:8 row_mask:0xf bank_mask:0xc
    v_add_f32_dpp v39, v19, v19 row_ror:8 row_mask:0xf bank_mask:0xc
    v_add_f32_dpp v36, v36, v36 row_half_mirror row_mask:0xf bank_mask:0x5
    v_add_f32_dpp v38, v38, v38 row_half_mirror row_mask:0xf bank_mask:0x5
    s_nop 0
    v_add_f32_dpp v36, v37, v37 row_half_mirror row_mask:0xf bank_mask:0xa
    v_add_f32_dpp v38, v39, v39 row_half_mirror row_mask:0xf bank_mask:0xa
    s_nop 0
    v_add_f32_dpp v36, v36, v36 quad_perm:[1,0,3,2] row_mask:0xf bank_mask:0xf
    v_add_f32_dpp v38, v38, v38 quad_perm:[1,0,3,2] row_mask:0xf bank_mask:0xf
    s_nop 0
    v_add_f32_dpp v36, v36, v36 quad_perm:[2,3,0,1] row_mask:0xf bank_mask:0xf
    v_add_f32_dpp v38, v38, v38 quad_perm:[2,3,0,1] row_mask:0xf bank_mask:0xf
    v_cndmask_b32 v28, v28, v36, s[22:23]
    v_cndmask_b32 v28, v28, v38, s[36:37]
    s_waitcnt vmcnt(34)
    s_cmp_gt_u32 s77, 10
    s_cbranch_scc1 Lw42
    s_waitcnt vmcnt(30)
    s_cmp_gt_u32 s77, 8
    s_cbranch_scc1 Lw42
    s_waitcnt vmcnt(22)
Lw42:
    v_dot2_f32_bf16 v12, v144, v8, 0
    v_dot2_f32_bf16 v13, v148, v8, 0
    v_dot2_f32_bf16 v14, v152, v8, 0
    v_dot2_f32_bf16 v15, v156, v8, 0
    v_dot2c_f32_bf16 v12, v145, v9
    v_dot2c_f32_bf16 v13, v149, v9
    v_dot2c_f32_bf16 v14, v153, v9
    v_dot2c_f32_bf16 v15, v157, v9
    v_dot2c_f32_bf16 v12, v146, v10
    v_dot2c_f32_bf16 v13, v150, v10
    v_dot2c_f32_bf16 v14, v154, v10
    v_dot2c_f32_bf16 v15, v158, v10
    v_dot2c_f32_bf16 v12, v147, v11
    v_dot2c_f32_bf16 v13, v151, v11
    v_dot2c_f32_bf16 v14, v155, v11
    v_dot2c_f32_bf16 v15, v159, v11
    v_dot2_f32_bf16 v16, v160, v8, 0
    v_dot2_f32_bf16 v17, v164, v8, 0
    v_dot2_f32_bf16 v18, v168, v8, 0
    v_dot2_f32_bf16 v19, v172, v8, 0
    v_dot2c_f32_bf16 v16, v161, v9
    v_dot2c_f32_bf16 v17, v165, v9
    v_dot2c_f32_bf16 v18, v169, v9
    v_dot2c_f32_bf16 v19, v173, v9
    v_dot2c_f32_bf16 v16, v162, v10
    v_dot2c_f32_bf16 v17, v166, v10
    v_dot2c_f32_bf16 v18, v170, v10
    v_dot2c_f32_bf16 v19, v174, v10
    v_dot2c_f32_bf16 v16, v163, v11
    v_dot2c_f32_bf16 v17, v167, v11
    v_dot2c_f32_bf16 v18, v171, v11
    v_dot2c_f32_bf16 v19, v175, v11
    v_add_f32_dpp v36, v12, v12 row_ror:8 row_mask:0xf bank_mask:0x3
    v_add_f32_dpp v37, v13, v13 row_ror:8 row_mask:0xf bank_mask:0x3
    v_add_f32_dpp v38, v16, v16 row_ror:8 row_mask:0xf bank_mask:0x3
    v_add_f32_dpp v39, v17, v17 row_ror:8 row_mask:0xf bank_mask:0x3
    v_add_f32_dpp v36, v14, v14 row_ror:8 row_mask:0xf bank_mask:0xc
    v_add_f32_dpp v37, v15, v15 row_ror:8 row_mask:0xf bank_mask:0xc
    v_add_f32_dpp v38, v18, v18 row_ror:8 row_mask:0xf bank_mask:0xc
    v_add_f32_dpp v39, v19, v19 row_ror:8 row_mask:0xf bank_mask:0xc
    v_add_f32_dpp v36, v36, v36 row_half_mirror row_mask:0xf bank_mask:0x5
    v_add_f32_dpp v38, v38, v38 row_half_mirror row_mask:0xf bank_mask:0x5
    s_nop 0
    v_add_f32_dpp v36, v37, v37 row_half_mirror row_mask:0xf bank_mask:0xa
    v_add_f32_dpp v38, v39, v39 row_half_mirror row_mask:0xf bank_mask:0xa
    s_nop 0
    v_add_f32_dpp v36, v36, v36 quad_perm:[1,0,3,2] row_mask:0xf bank_mask:0xf
    v_add_f32_dpp v38, v38, v38 quad_perm:[1,0,3,2] row_mask:0xf bank_mask:0xf
    s_nop 0
    v_add_f32_dpp v36, v36, v36 quad_perm:[2,3,0,1] row_mask:0xf bank_mask:0xf
    v_add_f32_dpp v38, v38, v38 quad_perm:[2,3,0,1] row_mask:0xf bank_mask:0xf
    v_cndmask_b32 v29, v29, v36, s[20:21]
    v_cndmask_b32 v29, v29, v38, s[22:23]
    s_add_u32 s86, s86, 0x2000
    buffer_load_dwordx2 v[88:89], v6, s[16:19], s86 offen offset:0
    buffer_load_dwordx2 v[90:91], v6, s[16:19], s86 offen offset:1024
    s_add_u32 s86, s86, 0x2000
    buffer_load_dwordx2 v[92:93], v6, s[16:19], s86 offen offset:0
    buffer_load_dwordx2 v[94:95], v6, s[16:19], s86 offen offset:1024
    s_and_b32 s98, s97, s71
    s_add_u32 s97, s97, s68
    buffer_load_dwordx4 v[144:147], v4, s[8:11], s98 offen nt
    s_and_b32 s98, s97, s71
    s_add_u32 s97, s97, s68
    buffer_load_dwordx4 v[148:151], v4, s[8:11], s98 offen nt
    s_and_b32 s98, s97, s71
    s_add_u32 s97, s97, s68
    buffer_load_dwordx4 v[152:155], v4, s[8:11], s98 offen nt
    s_and_b32 s98, s97, s71
    s_add_u32 s97, s97, s69
    buffer_load_dwordx4 v[156:159], v4, s[8:11], s98 offen nt
    s_waitcnt vmcnt(30)
    s_cmp_gt_u32 s77, 10
    s_cbranch_scc1 Lw43
    s_waitcnt vmcnt(26)
    s_cmp_gt_u32 s77, 8
    s_cbranch_scc1 Lw43
    s_waitcnt vmcnt(18)
Lw43:
    v_dot2_f32_bf16 v12, v176, v8, 0
    v_dot2_f32_bf16 v13, v180, v8, 0
    v_dot2_f32_bf16 v14, v184, v8, 0
    v_dot2_f32_bf16 v15, v188, v8, 0
    v_dot2c_f32_bf16 v12, v177, v9
    v_dot2c_f32_bf16 v13, v181, v9
    v_dot2c_f32_bf16 v14, v185, v9
    v_dot2c_f32_bf16 v15, v189, v9
    v_dot2c_f32_bf16 v12, v178, v10
    v_dot2c_f32_bf16 v13, v182, v10
    v_dot2c_f32_bf16 v14, v186, v10
    v_dot2c_f32_bf16 v15, v190, v10
    v_dot2c_f32_bf16 v12, v179, v11
    v_dot2c_f32_bf16 v13, v183, v11
    v_dot2c_f32_bf16 v14, v187, v11
    v_dot2c_f32_bf16 v15, v191, v11
    v_dot2_f32_bf16 v16, v192, v8, 0
    v_dot2_f32_bf16 v17, v196, v8, 0
    v_dot2_f32_bf16 v18, v200, v8, 0
    v_dot2_f32_bf16 v19, v204, v8, 0
    v_dot2c_f32_bf16 v16, v193, v9
    v_dot2c_f32_bf16 v17, v197, v9
    v_dot2c_f32_bf16 v18, v201, v9
    v_dot2c_f32_bf16 v19, v205, v9
    v_dot2c_f32_bf16 v16, v194, v10
    v_dot2c_f32_bf16 v17, v198, v10
    v_dot2c_f32_bf16 v18, v202, v10
    v_dot2c_f32_bf16 v19, v206, v10
    v_dot2c_f32_bf16 v16, v195, v11
    v_dot2c_f32_bf16 v17, v199, v11
    v_dot2c_f32_bf16 v18, v203, v11
    v_dot2c_f32_bf16 v19, v207, v11
    v_add_f32_dpp v36, v12, v12 row_ror:8 row_mask:0xf bank_mask:0x3
    v_add_f32_dpp v37, v13, v13 row_ror:8 row_mask:0xf bank_mask:0x3
    v_add_f32_dpp v38, v16, v16 row_ror:8 row_mask:0xf bank_mask:0x3
    v_add_f32_dpp v39, v17, v17 row_ror:8 row_mask:0xf bank_mask:0x3
    v_add_f32_dpp v36, v14, v14 row_ror:8 row_mask:0xf bank_mask:0xc
    v_add_f32_dpp v37, v15, v15 row_ror:8 row_mask:0xf bank_mask:0xc
    v_add_f32_dpp v38, v18, v18 row_ror:8 row_mask:0xf bank_mask:0xc
    v_add_f32_dpp v39, v19, v19 row_ror:8 row_mask:0xf bank_mask:0xc
    v_add_f32_dpp v36, v36, v36 row_half_mirror row_mask:0xf bank_mask:0x5
    v_add_f32_dpp v38, v38, v38 row_half_mirror row_mask:0xf bank_mask:0x5
    s_nop 0
    v_add_f32_dpp v36, v37, v37 row_half_mirror row_mask:0xf bank_mask:0xa
    v_add_f32_dpp v38, v39, v39 row_half_mirror row_mask:0xf bank_mask:0xa
    s_nop 0
    v_add_f32_dpp v36, v36, v36 quad_perm:[1,0,3,2] row_mask:0xf bank_mask:0xf
    v_add_f32_dpp v38, v38, v38 quad_perm:[1,0,3,2] row_mask:0xf bank_mask:0xf
    s_nop 0
    v_add_f32_dpp v36, v36, v36 quad_perm:[2,3,0,1] row_mask:0xf bank_mask:0xf
    v_add_f32_dpp v38, v38, v38 quad_perm:[2,3,0,1] row_mask:0xf bank_mask:0xf
    v_cndmask_b32 v29, v29, v36, s[36:37]
    v_cndmask_b32 v29, v29, v38, s[38:39]
    s_add_u32 s86, s86, 0x2000
    buffer_load_dwordx2 v[96:97], v6, s[16:19], s86 offen offset:0
    buffer_load_dwordx2 v[98:99], v6, s[16:19], s86 offen offset:1024
    s_add_u32 s86, s86, 0x2000
    buffer_load_dwordx2 v[100:101], v6, s[16:19], s86 offen offset:0
    buffer_load_dwordx2 v[102:103], v6, s[16:19], s86 offen offset:1024
    s_and_b32 s98, s97, s71
    s_add_u32 s97, s97, s68
    buffer_load_dwordx4 v[160:163], v4, s[8:11], s98 offen nt
    s_and_b32 s98, s97, s71
    s_add_u32 s97, s97, s68
    buffer_load_dwordx4 v[164:167], v4, s[8:11], s98 offen nt
    s_and_b32 s98, s97, s71
    s_add_u32 s97, s97, s68
    buffer_load_dwordx4 v[168:171], v4, s[8:11], s98 offen nt
    s_and_b32 s98, s97, s71
    s_add_u32 s97, s97, s69
    buffer_load_dwordx4 v[172:175], v4, s[8:11], s98 offen nt
    s_cmp_le_u32 s77, 8
    s_cbranch_scc1 Lsdone
    s_waitcnt vmcnt(28)
    s_cmp_gt_u32 s77, 10
    s_cbranch_scc1 Lw44
    s_waitcnt vmcnt(24)
Lw44:
    v_dot2_f32_bf16 v12, v208, v8, 0
    v_dot2_f32_bf16 v13, v212, v8, 0
    v_dot2_f32_bf16 v14, v216, v8, 0
    v_dot2_f32_bf16 v15, v220, v8, 0
    v_dot2c_f32_bf16 v12, v209, v9
    v_dot2c_f32_bf16 v13, v213, v9
    v_dot2c_f32_bf16 v14, v217, v9
    v_dot2c_f32_bf16 v15, v221, v9
    v_dot2c_f32_bf16 v12, v210, v10
    v_dot2c_f32_bf16 v13, v214, v10
    v_dot2c_f32_bf16 v14, v218, v10
    v_dot2c_f32_bf16 v15, v222, v10
    v_dot2c_f32_bf16 v12, v211, v11
    v_dot2c_f32_bf16 v13, v215, v11
    v_dot2c_f32_bf16 v14, v219, v11
    v_dot2c_f32_bf16 v15, v223, v11
    v_dot2_f32_bf16 v16, v224, v8, 0
    v_dot2_f32_bf16 v17, v228, v8, 0
    v_dot2_f32_bf16 v18, v232, v8, 0
    v_dot2_f32_bf16 v19, v236, v8, 0
    v_dot2c_f32_bf16 v16, v225, v9
    v_dot2c_f32_bf16 v17, v229, v9
    v_dot2c_f32_bf16 v18, v233, v9
    v_dot2c_f32_bf16 v19, v237, v9
    v_dot2c_f32_bf16 v16, v226, v10
    v_dot2c_f32_bf16 v17, v230, v10
    v_dot2c_f32_bf16 v18, v234, v10
    v_dot2c_f32_bf16 v19, v238, v10
    v_dot2c_f32_bf16 v16, v227, v11
    v_dot2c_f32_bf16 v17, v231, v11
    v_dot2c_f32_bf16 v18, v235, v11
    v_dot2c_f32_bf16 v19, v239, v11
    v_add_f32_dpp v36, v12, v12 row_ror:8 row_mask:0xf bank_mask:0x3
    v_add_f32_dpp v37, v13, v13 row_ror:8 row_mask:0xf bank_mask:0x3
    v_add_f32_dpp v38, v16, v16 row_ror:8 row_mask:0xf bank_mask:0x3
    v_add_f32_dpp v39, v17, v17 row_ror:8 row_mask:0xf bank_mask:0x3
    v_add_f32_dpp v36, v14, v14 row_ror:8 row_mask:0xf bank_mask:0xc
    v_add_f32_dpp v37, v15, v15 row_ror:8 row_mask:0xf bank_mask:0xc
    v_add_f32_dpp v38, v18, v18 row_ror:8 row_mask:0xf bank_mask:0xc
    v_add_f32_dpp v39, v19, v19 row_ror:8 row_mask:0xf bank_mask:0xc
    v_add_f32_dpp v36, v36, v36 row_half_mirror row_mask:0xf bank_mask:0x5
    v_add_f32_dpp v38, v38, v38 row_half_mirror row_mask:0xf bank_mask:0x5
    s_nop 0
    v_add_f32_dpp v36, v37, v37 row_half_mirror row_mask:0xf bank_mask:0xa
    v_add_f32_dpp v38, v39, v39 row_half_mirror row_mask:0xf bank_mask:0xa
    s_nop 0
    v_add_f32_dpp v36, v36, v36 quad_perm:[1,0,3,2] row_mask:0xf bank_mask:0xf
    v_add_f32_dpp v38, v38, v38 quad_perm:[1,0,3,2] row_mask:0xf bank_mask:0xf
    s_nop 0
    v_add_f32_dpp v36, v36, v36 quad_perm:[2,3,0,1] row_mask:0xf bank_mask:0xf
    v_add_f32_dpp v38, v38, v38 quad_perm:[2,3,0,1] row_mask:0xf bank_mask:0xf
    v_cndmask_b32 v30, v30, v36, s[20:21]
    v_cndmask_b32 v30, v30, v38, s[22:23]
    s_cmp_le_u32 s77, 10
    s_cbranch_scc1 Lsdone
    s_waitcnt vmcnt(24)
    v_dot2_f32_bf16 v12, v240, v8, 0
    v_dot2_f32_bf16 v13, v244, v8, 0
    v_dot2_f32_bf16 v14, v248, v8, 0
    v_dot2_f32_bf16 v15, v252, v8, 0
    v_dot2c_f32_bf16 v12, v241, v9
    v_dot2c_f32_bf16 v13, v245, v9
    v_dot2c_f32_bf16 v14, v249, v9
    v_dot2c_f32_bf16 v15, v253, v9
    v_dot2c_f32_bf16 v12, v242, v10
    v_dot2c_f32_bf16 v13, v246, v10
    v_dot2c_f32_bf16 v14, v250, v10
    v_dot2c_f32_bf16 v15, v254, v10
    v_dot2c_f32_bf16 v12, v243, v11
    v_dot2c_f32_bf16 v13, v247, v11
    v_dot2c_f32_bf16 v14, v251, v11
    v_dot2c_f32_bf16 v15, v255, v11
    v_add_f32_dpp v36, v12, v12 row_ror:8 row_mask:0xf bank_mask:0x3
    v_add_f32_dpp v37, v13, v13 row_ror:8 row_mask:0xf bank_mask:0x3
    s_nop 0
    v_add_f32_dpp v36, v14, v14 row_ror:8 row_mask:0xf bank_mask:0xc
    v_add_f32_dpp v37, v15, v15 row_ror:8 row_mask:0xf bank_mask:0xc
    s_nop 0
    v_add_f32_dpp v36, v36, v36 row_half_mirror row_mask:0xf bank_mask:0x5
    s_nop 1
    v_add_f32_dpp v36, v37, v37 row_half_mirror row_mask:0xf bank_mask:0xa
    s_nop 1
    v_add_f32_dpp v36, v36, v36 quad_perm:[1,0,3,2] row_mask:0xf bank_mask:0xf
    s_nop 1
    v_add_f32_dpp v36, v36, v36 quad_perm:[2,3,0,1] row_mask:0xf bank_mask:0xf
    v_cndmask_b32 v30, v30, v36, s[36:37]
Lsdone:
    v_cvt_pk_bf16_f32 v28, 0, v28
    v_cvt_pk_bf16_f32 v29, 0, v29
    v_cvt_pk_bf16_f32 v30, 0, v30
    v_mul_f32 v28, s84, v28
    v_mul_f32 v29, s84, v29
    v_mul_f32 v30, s84, v30
    v_cvt_pk_bf16_f32 v28, 0, v28
    v_cvt_pk_bf16_f32 v29, 0, v29
    v_cvt_pk_bf16_f32 v30, 0, v30
    v_max3_f32 v20, v28, v29, v30
    s_nop 1
    v_max_f32_dpp v20, v20, v20 row_ror:8 row_mask:0xf bank_mask:0xf
    s_nop 1
    v_max_f32_dpp v20, v20, v20 row_ror:4 row_mask:0xf bank_mask:0xf
    s_nop 1
    v_max_f32_dpp v20, v20, v20 row_ror:2 row_mask:0xf bank_mask:0xf
    s_nop 1
    v_max_f32_dpp v20, v20, v20 row_ror:1 row_mask:0xf bank_mask:0xf
    v_mov_b32 v36, v20
    s_nop 1
    v_permlane32_swap_b32 v20, v36
    v_max_f32 v20, v20, v36
    v_mov_b32 v36, v20
    s_nop 1
    v_permlane16_swap_b32 v20, v36
    v_max_f32 v20, v20, v36
    v_mul_f32 v20, s85, v20
    v_fma_f32 v28, v28, s85, -v20
    v_fma_f32 v29, v29, s85, -v20
    v_fma_f32 v30, v30, s85, -v20
    v_exp_f32 v28, v28
    v_exp_f32 v29, v29
    v_exp_f32 v30, v30
    s_lshl_b32 s78, s76, 3
    v_add_f32 v21, v28, v29
    v_add_f32 v21, v21, v30
    s_nop 1
    v_add_f32_dpp v21, v21, v21 row_ror:8 row_mask:0xf bank_mask:0xf
    s_nop 1
    v_add_f32_dpp v21, v21, v21 row_ror:4 row_mask:0xf bank_mask:0xf
    s_nop 1
    v_add_f32_dpp v21, v21, v21 row_ror:2 row_mask:0xf bank_mask:0xf
    s_nop 1
    v_add_f32_dpp v21, v21, v21 row_ror:1 row_mask:0xf bank_mask:0xf
    v_mov_b32 v36, v21
    s_nop 1
    v_permlane32_swap_b32 v21, v36
    v_add_f32 v21, v21, v36
    v_mov_b32 v36, v21
    s_nop 1
    v_permlane16_swap_b32 v21, v36
    v_add_f32 v21, v21, v36
    v_mov_b32 v36, s78
    s_mov_b64 exec, 1
    ds_write_b64 v36, v[20:21] offset:12288
    s_mov_b64 exec, -1
    s_add_u32 s86, s86, 0x2000
    buffer_load_dwordx2 v[104:105], v6, s[16:19], s86 offen offset:0
    buffer_load_dwordx2 v[106:107], v6, s[16:19], s86 offen offset:1024
    s_add_u32 s86, s86, 0x2000
    buffer_load_dwordx2 v[108:109], v6, s[16:19], s86 offen offset:0
    buffer_load_dwordx2 v[110:111], v6, s[16:19], s86 offen offset:1024
    s_and_b32 s98, s97, s71
    s_add_u32 s97, s97, s68
    buffer_load_dwordx4 v[176:179], v4, s[8:11], s98 offen nt
    s_and_b32 s98, s97, s71
    s_add_u32 s97, s97, s68
    buffer_load_dwordx4 v[180:183], v4, s[8:11], s98 offen nt
    s_and_b32 s98, s97, s71
    s_add_u32 s97, s97, s68
    buffer_load_dwordx4 v[184:187], v4, s[8:11], s98 offen nt
    s_and_b32 s98, s97, s71
    s_add_u32 s97, s97, s69
    buffer_load_dwordx4 v[188:191], v4, s[8:11], s98 offen nt
    s_waitcnt lgkmcnt(0)
    s_barrier
    ds_read_b64 v[38:39], v59 offset:12288
    v_mov_b32 v12, 0
    v_mov_b32 v13, 0
    v_mov_b32 v14, 0
    v_mov_b32 v15, 0
    v_mov_b32 v16, 0
    v_mov_b32 v17, 0
    v_mov_b32 v18, 0
    v_mov_b32 v19, 0
    v_mov_b32 v24, 0
    v_mov_b32 v25, 0
    v_mov_b32 v26, 0
    v_mov_b32 v27, 0
    s_waitcnt lgkmcnt(0)
    v_max_f32_dpp v42, v38, v38 row_ror:4 row_mask:0xf bank_mask:0xf
    s_nop 1
    v_max_f32_dpp v42, v42, v42 row_ror:2 row_mask:0xf bank_mask:0xf
    s_nop 1
    v_max_f32_dpp v42, v42, v42 row_ror:1 row_mask:0xf bank_mask:0xf
    v_sub_f32 v40, v38, v42
    v_sub_f32 v23, v20, v42
    v_exp_f32 v40, v40
    v_exp_f32 v23, v23
    v_mul_f32 v41, v40, v39
    s_nop 1
    v_add_f32_dpp v41, v41, v41 row_ror:4 row_mask:0xf bank_mask:0xf
    s_nop 1
    v_add_f32_dpp v41, v41, v41 row_ror:2 row_mask:0xf bank_mask:0xf
    s_nop 1
    v_add_f32_dpp v41, v41, v41 row_ror:1 row_mask:0xf bank_mask:0xf
    v_rcp_f32 v40, v41
    v_log_f32 v22, v41
    v_mul_f32 v23, v23, v40
    v_add_f32 v22, v22, v42
    v_mul_f32 v28, v23, v28
    v_mul_f32 v29, v23, v29
    v_mul_f32 v30, v23, v30
    v_cvt_pk_bf16_f32 v32, 0, v28
    v_cvt_pk_bf16_f32 v33, 0, v29
    v_cvt_pk_bf16_f32 v34, 0, v30
    v_cvt_pk_bf16_f32 v28, v28, 0
    v_cvt_pk_bf16_f32 v29, v29, 0
    v_cvt_pk_bf16_f32 v30, v30, 0
    v_max_u32 v22, s3, v22
    v_not_b32 v0, v0
    v_lshrrev_b32 v36, v57, v55
    v_lshlrev_b32 v36, 3, v36
    v_bfi_b32 v0, 1, v0, v36
    v_lshrrev_b32 v22, v57, v22
    v_lshlrev_b32 v22, 1, v22
    v_bfi_b32 v0, 6, v22, v0
    v_lshrrev_b32 v53, 3, v3
    v_lshlrev_b32 v53, 10, v53
    v_and_b32 v36, 1, v3
    v_lshl_add_u32 v53, v36, 6, v53
    v_cmp_eq_u32 vcc, 1, v36
    v_bfe_u32 v36, v3, 2, 1
    v_lshl_add_u32 v53, v36, 5, v53
    v_lshl_add_u32 v53, v2, 3, v53
    v_bfe_u32 v36, v3, 1, 1
    v_lshl_add_u32 v53, v36, 2, v53
    s_lshl_b32 s78, s76, 7
    v_add_u32 v53, s78, v53
    v_lshlrev_b32 v52, 6, v3
    v_lshl_add_u32 v52, v2, 4, v52
    v_mov_b32 v59, 0x4444
    v_mov_b32 v36, 0xeeee
    v_cndmask_b32 v59, v59, v36, vcc
    v_mov_b32 v36, 0
    v_mov_b32 v37, 0
    v_mov_b32 v38, 0
    v_mov_b32 v39, 0
    v_mov_b32 v40, 0
    v_mov_b32 v41, 0
    v_mov_b32 v42, 0
    v_mov_b32 v43, 0
    v_mov_b32 v44, 0
    v_mov_b32 v45, 0
    v_mov_b32 v46, 0
    v_mov_b32 v47, 0
    v_mov_b32 v48, 0
    v_mov_b32 v49, 0
    v_mov_b32 v50, 0
    v_mov_b32 v51, 0
    s_waitcnt vmcnt(24)
    v_dot2c_f32_bf16_dpp v12, v28, v128 row_newbcast:0 row_mask:0xf bank_mask:0xf
    v_dot2c_f32_bf16_dpp v13, v32, v128 row_newbcast:0 row_mask:0xf bank_mask:0xf
    v_dot2c_f32_bf16_dpp v14, v28, v129 row_newbcast:0 row_mask:0xf bank_mask:0xf
    v_dot2c_f32_bf16_dpp v15, v32, v129 row_newbcast:0 row_mask:0xf bank_mask:0xf
    v_dot2c_f32_bf16_dpp v16, v28, v130 row_newbcast:0 row_mask:0xf bank_mask:0xf
    v_dot2c_f32_bf16_dpp v17, v32, v130 row_newbcast:0 row_mask:0xf bank_mask:0xf
    v_dot2c_f32_bf16_dpp v18, v28, v131 row_newbcast:0 row_mask:0xf bank_mask:0xf
    v_dot2c_f32_bf16_dpp v19, v32, v131 row_newbcast:0 row_mask:0xf bank_mask:0xf
    v_dot2c_f32_bf16_dpp v12, v28, v132 row_newbcast:4 row_mask:0xf bank_mask:0xf
    v_dot2c_f32_bf16_dpp v13, v32, v132 row_newbcast:4 row_mask:0xf bank_mask:0xf
    v_dot2c_f32_bf16_dpp v14, v28, v133 row_newbcast:4 row_mask:0xf bank_mask:0xf
    v_dot2c_f32_bf16_dpp v15, v32, v133 row_newbcast:4 row_mask:0xf bank_mask:0xf
    v_dot2c_f32_bf16_dpp v16, v28, v134 row_newbcast:4 row_mask:0xf bank_mask:0xf
    v_dot2c_f32_bf16_dpp v17, v32, v134 row_newbcast:4 row_mask:0xf bank_mask:0xf
    v_dot2c_f32_bf16_dpp v18, v28, v135 row_newbcast:4 row_mask:0xf bank_mask:0xf
    v_dot2c_f32_bf16_dpp v19, v32, v135 row_newbcast:4 row_mask:0xf bank_mask:0xf
    v_dot2c_f32_bf16_dpp v12, v28, v136 row_newbcast:8 row_mask:0xf bank_mask:0xf
    v_dot2c_f32_bf16_dpp v13, v32, v136 row_newbcast:8 row_mask:0xf bank_mask:0xf
    v_dot2c_f32_bf16_dpp v14, v28, v137 row_newbcast:8 row_mask:0xf bank_mask:0xf
    v_dot2c_f32_bf16_dpp v15, v32, v137 row_newbcast:8 row_mask:0xf bank_mask:0xf
    v_dot2c_f32_bf16_dpp v16, v28, v138 row_newbcast:8 row_mask:0xf bank_mask:0xf
    v_dot2c_f32_bf16_dpp v17, v32, v138 row_newbcast:8 row_mask:0xf bank_mask:0xf
    v_dot2c_f32_bf16_dpp v18, v28, v139 row_newbcast:8 row_mask:0xf bank_mask:0xf
    v_dot2c_f32_bf16_dpp v19, v32, v139 row_newbcast:8 row_mask:0xf bank_mask:0xf
    v_dot2c_f32_bf16_dpp v12, v28, v140 row_newbcast:12 row_mask:0xf bank_mask:0xf
    v_dot2c_f32_bf16_dpp v13, v32, v140 row_newbcast:12 row_mask:0xf bank_mask:0xf
    v_dot2c_f32_bf16_dpp v14, v28, v141 row_newbcast:12 row_mask:0xf bank_mask:0xf
    v_dot2c_f32_bf16_dpp v15, v32, v141 row_newbcast:12 row_mask:0xf bank_mask:0xf
    v_dot2c_f32_bf16_dpp v16, v28, v142 row_newbcast:12 row_mask:0xf bank_mask:0xf
    v_dot2c_f32_bf16_dpp v17, v32, v142 row_newbcast:12 row_mask:0xf bank_mask:0xf
    v_dot2c_f32_bf16_dpp v18, v28, v143 row_newbcast:12 row_mask:0xf bank_mask:0xf
    v_dot2c_f32_bf16_dpp v19, v32, v143 row_newbcast:12 row_mask:0xf bank_mask:0xf
    s_add_u32 s86, s86, 0x2000
    buffer_load_dwordx2 v[112:113], v6, s[16:19], s86 offen offset:0
    buffer_load_dwordx2 v[114:115], v6, s[16:19], s86 offen offset:1024
    s_add_u32 s86, s86, 0x2000
    buffer_load_dwordx2 v[116:117], v6, s[16:19], s86 offen offset:0
    buffer_load_dwordx2 v[118:119], v6, s[16:19], s86 offen offset:1024
    s_and_b32 s98, s97, s71
    s_add_u32 s97, s97, s68
    buffer_load_dwordx4 v[128:131], v4, s[8:11], s98 offen nt
    s_and_b32 s98, s97, s71
    s_add_u32 s97, s97, s68
    buffer_load_dwordx4 v[132:135], v4, s[8:11], s98 offen nt
    s_and_b32 s98, s97, s71
    s_add_u32 s97, s97, s68
    buffer_load_dwordx4 v[136:139], v4, s[8:11], s98 offen nt
    s_and_b32 s98, s97, s71
    s_add_u32 s97, s97, s69
    buffer_load_dwordx4 v[140:143], v4, s[8:11], s98 offen nt
    v_perm_b32 v192, v66, v64, s82
    v_perm_b32 v200, v66, v64, s83
    v_perm_b32 v208, v67, v65, s82
    v_perm_b32 v216, v67, v65, s83
    v_perm_b32 v193, v70, v68, s82
    v_perm_b32 v201, v70, v68, s83
    v_perm_b32 v209, v71, v69, s82
    v_perm_b32 v217, v71, v69, s83
    v_perm_b32 v194, v74, v72, s82
    v_perm_b32 v202, v74, v72, s83
    v_perm_b32 v210, v75, v73, s82
    v_perm_b32 v218, v75, v73, s83
    v_perm_b32 v195, v78, v76, s82
    v_perm_b32 v203, v78, v76, s83
    v_perm_b32 v211, v79, v77, s82
    v_perm_b32 v219, v79, v77, s83
    v_perm_b32 v196, v82, v80, s82
    v_perm_b32 v204, v82, v80, s83
    v_perm_b32 v212, v83, v81, s82
    v_perm_b32 v220, v83, v81, s83
    v_perm_b32 v197, v86, v84, s82
    v_perm_b32 v205, v86, v84, s83
    v_perm_b32 v213, v87, v85, s82
    v_perm_b32 v221, v87, v85, s83
    s_waitcnt vmcnt(24)
    v_dot2c_f32_bf16_dpp v12, v28, v144 row_newbcast:1 row_mask:0xf bank_mask:0xf
    v_dot2c_f32_bf16_dpp v13, v32, v144 row_newbcast:1 row_mask:0xf bank_mask:0xf
    v_dot2c_f32_bf16_dpp v14, v28, v145 row_newbcast:1 row_mask:0xf bank_mask:0xf
    v_dot2c_f32_bf16_dpp v15, v32, v145 row_newbcast:1 row_mask:0xf bank_mask:0xf
    v_dot2c_f32_bf16_dpp v16, v28, v146 row_newbcast:1 row_mask:0xf bank_mask:0xf
    v_dot2c_f32_bf16_dpp v17, v32, v146 row_newbcast:1 row_mask:0xf bank_mask:0xf
    v_dot2c_f32_bf16_dpp v18, v28, v147 row_newbcast:1 row_mask:0xf bank_mask:0xf
    v_dot2c_f32_bf16_dpp v19, v32, v147 row_newbcast:1 row_mask:0xf bank_mask:0xf
    v_dot2c_f32_bf16_dpp v12, v28, v148 row_newbcast:5 row_mask:0xf bank_mask:0xf
    v_dot2c_f32_bf16_dpp v13, v32, v148 row_newbcast:5 row_mask:0xf bank_mask:0xf
    v_dot2c_f32_bf16_dpp v14, v28, v149 row_newbcast:5 row_mask:0xf bank_mask:0xf
    v_dot2c_f32_bf16_dpp v15, v32, v149 row_newbcast:5 row_mask:0xf bank_mask:0xf
    v_dot2c_f32_bf16_dpp v16, v28, v150 row_newbcast:5 row_mask:0xf bank_mask:0xf
    v_dot2c_f32_bf16_dpp v17, v32, v150 row_newbcast:5 row_mask:0xf bank_mask:0xf
    v_dot2c_f32_bf16_dpp v18, v28, v151 row_newbcast:5 row_mask:0xf bank_mask:0xf
    v_dot2c_f32_bf16_dpp v19, v32, v151 row_newbcast:5 row_mask:0xf bank_mask:0xf
    v_dot2c_f32_bf16_dpp v12, v28, v152 row_newbcast:9 row_mask:0xf bank_mask:0xf
    v_dot2c_f32_bf16_dpp v13, v32, v152 row_newbcast:9 row_mask:0xf bank_mask:0xf
    v_dot2c_f32_bf16_dpp v14, v28, v153 row_newbcast:9 row_mask:0xf bank_mask:0xf
    v_dot2c_f32_bf16_dpp v15, v32, v153 row_newbcast:9 row_mask:0xf bank_mask:0xf
    v_dot2c_f32_bf16_dpp v16, v28, v154 row_newbcast:9 row_mask:0xf bank_mask:0xf
    v_dot2c_f32_bf16_dpp v17, v32, v154 row_newbcast:9 row_mask:0xf bank_mask:0xf
    v_dot2c_f32_bf16_dpp v18, v28, v155 row_newbcast:9 row_mask:0xf bank_mask:0xf
    v_dot2c_f32_bf16_dpp v19, v32, v155 row_newbcast:9 row_mask:0xf bank_mask:0xf
    v_dot2c_f32_bf16_dpp v12, v28, v156 row_newbcast:13 row_mask:0xf bank_mask:0xf
    v_dot2c_f32_bf16_dpp v13, v32, v156 row_newbcast:13 row_mask:0xf bank_mask:0xf
    v_dot2c_f32_bf16_dpp v14, v28, v157 row_newbcast:13 row_mask:0xf bank_mask:0xf
    v_dot2c_f32_bf16_dpp v15, v32, v157 row_newbcast:13 row_mask:0xf bank_mask:0xf
    v_dot2c_f32_bf16_dpp v16, v28, v158 row_newbcast:13 row_mask:0xf bank_mask:0xf
    v_dot2c_f32_bf16_dpp v17, v32, v158 row_newbcast:13 row_mask:0xf bank_mask:0xf
    v_dot2c_f32_bf16_dpp v18, v28, v159 row_newbcast:13 row_mask:0xf bank_mask:0xf
    v_dot2c_f32_bf16_dpp v19, v32, v159 row_newbcast:13 row_mask:0xf bank_mask:0xf
    s_add_u32 s86, s86, 0x2000
    buffer_load_dwordx2 v[120:121], v6, s[16:19], s86 offen offset:0
    buffer_load_dwordx2 v[122:123], v6, s[16:19], s86 offen offset:1024
    s_add_u32 s86, s86, 0x2000
    buffer_load_dwordx2 v[124:125], v6, s[16:19], s86 offen offset:0
    buffer_load_dwordx2 v[126:127], v6, s[16:19], s86 offen offset:1024
    s_and_b32 s98, s97, s71
    s_add_u32 s97, s97, s68
    buffer_load_dwordx4 v[144:147], v4, s[8:11], s98 offen nt
    s_and_b32 s98, s97, s71
    s_add_u32 s97, s97, s68
    buffer_load_dwordx4 v[148:151], v4, s[8:11], s98 offen nt
    s_and_b32 s98, s97, s71
    s_add_u32 s97, s97, s68
    buffer_load_dwordx4 v[152:155], v4, s[8:11], s98 offen nt
    s_and_b32 s98, s97, s71
    s_add_u32 s97, s97, s69
    buffer_load_dwordx4 v[156:159], v4, s[8:11], s98 offen nt
    v_perm_b32 v198, v90, v88, s82
    v_perm_b32 v206, v90, v88, s83
    v_perm_b32 v214, v91, v89, s82
    v_perm_b32 v222, v91, v89, s83
    v_perm_b32 v199, v94, v92, s82
    v_perm_b32 v207, v94, v92, s83
    v_perm_b32 v215, v95, v93, s82
    v_perm_b32 v223, v95, v93, s83
    s_waitcnt vmcnt(24)
    v_dot2c_f32_bf16_dpp v12, v28, v160 row_newbcast:2 row_mask:0xf bank_mask:0xf
    v_dot2c_f32_bf16_dpp v13, v32, v160 row_newbcast:2 row_mask:0xf bank_mask:0xf
    v_dot2c_f32_bf16_dpp v14, v28, v161 row_newbcast:2 row_mask:0xf bank_mask:0xf
    v_dot2c_f32_bf16_dpp v15, v32, v161 row_newbcast:2 row_mask:0xf bank_mask:0xf
    v_dot2c_f32_bf16_dpp v16, v28, v162 row_newbcast:2 row_mask:0xf bank_mask:0xf
    v_dot2c_f32_bf16_dpp v17, v32, v162 row_newbcast:2 row_mask:0xf bank_mask:0xf
    v_dot2c_f32_bf16_dpp v18, v28, v163 row_newbcast:2 row_mask:0xf bank_mask:0xf
    v_dot2c_f32_bf16_dpp v19, v32, v163 row_newbcast:2 row_mask:0xf bank_mask:0xf
    v_dot2c_f32_bf16_dpp v12, v28, v164 row_newbcast:6 row_mask:0xf bank_mask:0xf
    v_dot2c_f32_bf16_dpp v13, v32, v164 row_newbcast:6 row_mask:0xf bank_mask:0xf
    v_dot2c_f32_bf16_dpp v14, v28, v165 row_newbcast:6 row_mask:0xf bank_mask:0xf
    v_dot2c_f32_bf16_dpp v15, v32, v165 row_newbcast:6 row_mask:0xf bank_mask:0xf
    v_dot2c_f32_bf16_dpp v16, v28, v166 row_newbcast:6 row_mask:0xf bank_mask:0xf
    v_dot2c_f32_bf16_dpp v17, v32, v166 row_newbcast:6 row_mask:0xf bank_mask:0xf
    v_dot2c_f32_bf16_dpp v18, v28, v167 row_newbcast:6 row_mask:0xf bank_mask:0xf
    v_dot2c_f32_bf16_dpp v19, v32, v167 row_newbcast:6 row_mask:0xf bank_mask:0xf
    v_dot2c_f32_bf16_dpp v12, v28, v168 row_newbcast:10 row_mask:0xf bank_mask:0xf
    v_dot2c_f32_bf16_dpp v13, v32, v168 row_newbcast:10 row_mask:0xf bank_mask:0xf
    v_dot2c_f32_bf16_dpp v14, v28, v169 row_newbcast:10 row_mask:0xf bank_mask:0xf
    v_dot2c_f32_bf16_dpp v15, v32, v169 row_newbcast:10 row_mask:0xf bank_mask:0xf
    v_dot2c_f32_bf16_dpp v16, v28, v170 row_newbcast:10 row_mask:0xf bank_mask:0xf
    v_dot2c_f32_bf16_dpp v17, v32, v170 row_newbcast:10 row_mask:0xf bank_mask:0xf
    v_dot2c_f32_bf16_dpp v18, v28, v171 row_newbcast:10 row_mask:0xf bank_mask:0xf
    v_dot2c_f32_bf16_dpp v19, v32, v171 row_newbcast:10 row_mask:0xf bank_mask:0xf
    v_dot2c_f32_bf16_dpp v12, v28, v172 row_newbcast:14 row_mask:0xf bank_mask:0xf
    v_dot2c_f32_bf16_dpp v13, v32, v172 row_newbcast:14 row_mask:0xf bank_mask:0xf
    v_dot2c_f32_bf16_dpp v14, v28, v173 row_newbcast:14 row_mask:0xf bank_mask:0xf
    v_dot2c_f32_bf16_dpp v15, v32, v173 row_newbcast:14 row_mask:0xf bank_mask:0xf
    v_dot2c_f32_bf16_dpp v16, v28, v174 row_newbcast:14 row_mask:0xf bank_mask:0xf
    v_dot2c_f32_bf16_dpp v17, v32, v174 row_newbcast:14 row_mask:0xf bank_mask:0xf
    v_dot2c_f32_bf16_dpp v18, v28, v175 row_newbcast:14 row_mask:0xf bank_mask:0xf
    v_dot2c_f32_bf16_dpp v19, v32, v175 row_newbcast:14 row_mask:0xf bank_mask:0xf
    s_and_b32 s98, s97, s71
    s_add_u32 s97, s97, s68
    buffer_load_dwordx4 v[160:163], v4, s[8:11], s98 offen nt
    s_and_b32 s98, s97, s71
    s_add_u32 s97, s97, s68
    buffer_load_dwordx4 v[164:167], v4, s[8:11], s98 offen nt
    s_and_b32 s98, s97, s71
    s_add_u32 s97, s97, s68
    buffer_load_dwordx4 v[168:171], v4, s[8:11], s98 offen nt
    s_and_b32 s98, s97, s71
    s_add_u32 s97, s97, s69
    buffer_load_dwordx4 v[172:175], v4, s[8:11], s98 offen nt
    v_perm_b32 v224, v98, v96, s82
    v_perm_b32 v232, v98, v96, s83
    v_perm_b32 v240, v99, v97, s82
    v_perm_b32 v248, v99, v97, s83
    v_perm_b32 v225, v102, v100, s82
    v_perm_b32 v233, v102, v100, s83
    v_perm_b32 v241, v103, v101, s82
    v_perm_b32 v249, v103, v101, s83
    s_waitcnt vmcnt(20)
    v_dot2c_f32_bf16_dpp v12, v28, v176 row_newbcast:3 row_mask:0xf bank_mask:0xf
    v_dot2c_f32_bf16_dpp v13, v32, v176 row_newbcast:3 row_mask:0xf bank_mask:0xf
    v_dot2c_f32_bf16_dpp v14, v28, v177 row_newbcast:3 row_mask:0xf bank_mask:0xf
    v_dot2c_f32_bf16_dpp v15, v32, v177 row_newbcast:3 row_mask:0xf bank_mask:0xf
    v_dot2c_f32_bf16_dpp v16, v28, v178 row_newbcast:3 row_mask:0xf bank_mask:0xf
    v_dot2c_f32_bf16_dpp v17, v32, v178 row_newbcast:3 row_mask:0xf bank_mask:0xf
    v_dot2c_f32_bf16_dpp v18, v28, v179 row_newbcast:3 row_mask:0xf bank_mask:0xf
    v_dot2c_f32_bf16_dpp v19, v32, v179 row_newbcast:3 row_mask:0xf bank_mask:0xf
    v_dot2c_f32_bf16_dpp v12, v28, v180 row_newbcast:7 row_mask:0xf bank_mask:0xf
    v_dot2c_f32_bf16_dpp v13, v32, v180 row_newbcast:7 row_mask:0xf bank_mask:0xf
    v_dot2c_f32_bf16_dpp v14, v28, v181 row_newbcast:7 row_mask:0xf bank_mask:0xf
    v_dot2c_f32_bf16_dpp v15, v32, v181 row_newbcast:7 row_mask:0xf bank_mask:0xf
    v_dot2c_f32_bf16_dpp v16, v28, v182 row_newbcast:7 row_mask:0xf bank_mask:0xf
    v_dot2c_f32_bf16_dpp v17, v32, v182 row_newbcast:7 row_mask:0xf bank_mask:0xf
    v_dot2c_f32_bf16_dpp v18, v28, v183 row_newbcast:7 row_mask:0xf bank_mask:0xf
    v_dot2c_f32_bf16_dpp v19, v32, v183 row_newbcast:7 row_mask:0xf bank_mask:0xf
    v_dot2c_f32_bf16_dpp v12, v28, v184 row_newbcast:11 row_mask:0xf bank_mask:0xf
    v_dot2c_f32_bf16_dpp v13, v32, v184 row_newbcast:11 row_mask:0xf bank_mask:0xf
    v_dot2c_f32_bf16_dpp v14, v28, v185 row_newbcast:11 row_mask:0xf bank_mask:0xf
    v_dot2c_f32_bf16_dpp v15, v32, v185 row_newbcast:11 row_mask:0xf bank_mask:0xf
    v_dot2c_f32_bf16_dpp v16, v28, v186 row_newbcast:11 row_mask:0xf bank_mask:0xf
    v_dot2c_f32_bf16_dpp v17, v32, v186 row_newbcast:11 row_mask:0xf bank_mask:0xf
    v_dot2c_f32_bf16_dpp v18, v28, v187 row_newbcast:11 row_mask:0xf bank_mask:0xf
    v_dot2c_f32_bf16_dpp v19, v32, v187 row_newbcast:11 row_mask:0xf bank_mask:0xf
    v_dot2c_f32_bf16_dpp v12, v28, v188 row_newbcast:15 row_mask:0xf bank_mask:0xf
    v_dot2c_f32_bf16_dpp v13, v32, v188 row_newbcast:15 row_mask:0xf bank_mask:0xf
    v_dot2c_f32_bf16_dpp v14, v28, v189 row_newbcast:15 row_mask:0xf bank_mask:0xf
    v_dot2c_f32_bf16_dpp v15, v32, v189 row_newbcast:15 row_mask:0xf bank_mask:0xf
    v_dot2c_f32_bf16_dpp v16, v28, v190 row_newbcast:15 row_mask:0xf bank_mask:0xf
    v_dot2c_f32_bf16_dpp v17, v32, v190 row_newbcast:15 row_mask:0xf bank_mask:0xf
    v_dot2c_f32_bf16_dpp v18, v28, v191 row_newbcast:15 row_mask:0xf bank_mask:0xf
    v_dot2c_f32_bf16_dpp v19, v32, v191 row_newbcast:15 row_mask:0xf bank_mask:0xf
    s_and_b32 s98, s97, s71
    s_add_u32 s97, s97, s68
    buffer_load_dwordx4 v[176:179], v4, s[8:11], s98 offen nt
    s_and_b32 s98, s97, s71
    s_add_u32 s97, s97, s68
    buffer_load_dwordx4 v[180:183], v4, s[8:11], s98 offen nt
    s_and_b32 s98, s97, s71
    s_add_u32 s97, s97, s68
    buffer_load_dwordx4 v[184:187], v4, s[8:11], s98 offen nt
    s_and_b32 s98, s97, s71
    s_add_u32 s97, s97, s69
    buffer_load_dwordx4 v[188:191], v4, s[8:11], s98 offen nt
    v_perm_b32 v226, v106, v104, s82
    v_perm_b32 v234, v106, v104, s83
    v_perm_b32 v242, v107, v105, s82
    v_perm_b32 v250, v107, v105, s83
    v_perm_b32 v227, v110, v108, s82
    v_perm_b32 v235, v110, v108, s83
    v_perm_b32 v243, v111, v109, s82
    v_perm_b32 v251, v111, v109, s83
    s_waitcnt vmcnt(16)
    v_dot2c_f32_bf16_dpp v12, v29, v128 row_newbcast:0 row_mask:0xf bank_mask:0xf
    v_dot2c_f32_bf16_dpp v13, v33, v128 row_newbcast:0 row_mask:0xf bank_mask:0xf
    v_dot2c_f32_bf16_dpp v14, v29, v129 row_newbcast:0 row_mask:0xf bank_mask:0xf
    v_dot2c_f32_bf16_dpp v15, v33, v129 row_newbcast:0 row_mask:0xf bank_mask:0xf
    v_dot2c_f32_bf16_dpp v16, v29, v130 row_newbcast:0 row_mask:0xf bank_mask:0xf
    v_dot2c_f32_bf16_dpp v17, v33, v130 row_newbcast:0 row_mask:0xf bank_mask:0xf
    v_dot2c_f32_bf16_dpp v18, v29, v131 row_newbcast:0 row_mask:0xf bank_mask:0xf
    v_dot2c_f32_bf16_dpp v19, v33, v131 row_newbcast:0 row_mask:0xf bank_mask:0xf
    v_dot2c_f32_bf16_dpp v12, v29, v132 row_newbcast:4 row_mask:0xf bank_mask:0xf
    v_dot2c_f32_bf16_dpp v13, v33, v132 row_newbcast:4 row_mask:0xf bank_mask:0xf
    v_dot2c_f32_bf16_dpp v14, v29, v133 row_newbcast:4 row_mask:0xf bank_mask:0xf
    v_dot2c_f32_bf16_dpp v15, v33, v133 row_newbcast:4 row_mask:0xf bank_mask:0xf
    v_dot2c_f32_bf16_dpp v16, v29, v134 row_newbcast:4 row_mask:0xf bank_mask:0xf
    v_dot2c_f32_bf16_dpp v17, v33, v134 row_newbcast:4 row_mask:0xf bank_mask:0xf
    v_dot2c_f32_bf16_dpp v18, v29, v135 row_newbcast:4 row_mask:0xf bank_mask:0xf
    v_dot2c_f32_bf16_dpp v19, v33, v135 row_newbcast:4 row_mask:0xf bank_mask:0xf
    v_dot2c_f32_bf16_dpp v12, v29, v136 row_newbcast:8 row_mask:0xf bank_mask:0xf
    v_dot2c_f32_bf16_dpp v13, v33, v136 row_newbcast:8 row_mask:0xf bank_mask:0xf
    v_dot2c_f32_bf16_dpp v14, v29, v137 row_newbcast:8 row_mask:0xf bank_mask:0xf
    v_dot2c_f32_bf16_dpp v15, v33, v137 row_newbcast:8 row_mask:0xf bank_mask:0xf
    v_dot2c_f32_bf16_dpp v16, v29, v138 row_newbcast:8 row_mask:0xf bank_mask:0xf
    v_dot2c_f32_bf16_dpp v17, v33, v138 row_newbcast:8 row_mask:0xf bank_mask:0xf
    v_dot2c_f32_bf16_dpp v18, v29, v139 row_newbcast:8 row_mask:0xf bank_mask:0xf
    v_dot2c_f32_bf16_dpp v19, v33, v139 row_newbcast:8 row_mask:0xf bank_mask:0xf
    v_dot2c_f32_bf16_dpp v12, v29, v140 row_newbcast:12 row_mask:0xf bank_mask:0xf
    v_dot2c_f32_bf16_dpp v13, v33, v140 row_newbcast:12 row_mask:0xf bank_mask:0xf
    v_dot2c_f32_bf16_dpp v14, v29, v141 row_newbcast:12 row_mask:0xf bank_mask:0xf
    v_dot2c_f32_bf16_dpp v15, v33, v141 row_newbcast:12 row_mask:0xf bank_mask:0xf
    v_dot2c_f32_bf16_dpp v16, v29, v142 row_newbcast:12 row_mask:0xf bank_mask:0xf
    v_dot2c_f32_bf16_dpp v17, v33, v142 row_newbcast:12 row_mask:0xf bank_mask:0xf
    v_dot2c_f32_bf16_dpp v18, v29, v143 row_newbcast:12 row_mask:0xf bank_mask:0xf
    v_dot2c_f32_bf16_dpp v19, v33, v143 row_newbcast:12 row_mask:0xf bank_mask:0xf
    s_cmp_le_u32 s77, 8
    s_cbranch_scc1 Lw51
    s_and_b32 s98, s97, s71
    s_add_u32 s97, s97, s68
    buffer_load_dwordx4 v[128:131], v4, s[8:11], s98 offen nt
    s_and_b32 s98, s97, s71
    s_add_u32 s97, s97, s68
    buffer_load_dwordx4 v[132:135], v4, s[8:11], s98 offen nt
    s_and_b32 s98, s97, s71
    s_add_u32 s97, s97, s68
    buffer_load_dwordx4 v[136:139], v4, s[8:11], s98 offen nt
    s_and_b32 s98, s97, s71
    s_add_u32 s97, s97, s69
    buffer_load_dwordx4 v[140:143], v4, s[8:11], s98 offen nt
Lw51:
    v_perm_b32 v228, v114, v112, s82
    v_perm_b32 v236, v114, v112, s83
    v_perm_b32 v244, v115, v113, s82
    v_perm_b32 v252, v115, v113, s83
    v_perm_b32 v229, v118, v116, s82
    v_perm_b32 v237, v118, v116, s83
    v_perm_b32 v245, v119, v117, s82
    v_perm_b32 v253, v119, v117, s83
    s_waitcnt vmcnt(12)
    s_cmp_gt_u32 s77, 8
    s_cbranch_scc1 Lw52
    s_waitcnt vmcnt(8)
Lw52:
    v_dot2c_f32_bf16_dpp v12, v29, v144 row_newbcast:1 row_mask:0xf bank_mask:0xf
    v_dot2c_f32_bf16_dpp v13, v33, v144 row_newbcast:1 row_mask:0xf bank_mask:0xf
    v_dot2c_f32_bf16_dpp v14, v29, v145 row_newbcast:1 row_mask:0xf bank_mask:0xf
    v_dot2c_f32_bf16_dpp v15, v33, v145 row_newbcast:1 row_mask:0xf bank_mask:0xf
    v_dot2c_f32_bf16_dpp v16, v29, v146 row_newbcast:1 row_mask:0xf bank_mask:0xf
    v_dot2c_f32_bf16_dpp v17, v33, v146 row_newbcast:1 row_mask:0xf bank_mask:0xf
    v_dot2c_f32_bf16_dpp v18, v29, v147 row_newbcast:1 row_mask:0xf bank_mask:0xf
    v_dot2c_f32_bf16_dpp v19, v33, v147 row_newbcast:1 row_mask:0xf bank_mask:0xf
    v_dot2c_f32_bf16_dpp v12, v29, v148 row_newbcast:5 row_mask:0xf bank_mask:0xf
    v_dot2c_f32_bf16_dpp v13, v33, v148 row_newbcast:5 row_mask:0xf bank_mask:0xf
    v_dot2c_f32_bf16_dpp v14, v29, v149 row_newbcast:5 row_mask:0xf bank_mask:0xf
    v_dot2c_f32_bf16_dpp v15, v33, v149 row_newbcast:5 row_mask:0xf bank_mask:0xf
    v_dot2c_f32_bf16_dpp v16, v29, v150 row_newbcast:5 row_mask:0xf bank_mask:0xf
    v_dot2c_f32_bf16_dpp v17, v33, v150 row_newbcast:5 row_mask:0xf bank_mask:0xf
    v_dot2c_f32_bf16_dpp v18, v29, v151 row_newbcast:5 row_mask:0xf bank_mask:0xf
    v_dot2c_f32_bf16_dpp v19, v33, v151 row_newbcast:5 row_mask:0xf bank_mask:0xf
    v_dot2c_f32_bf16_dpp v12, v29, v152 row_newbcast:9 row_mask:0xf bank_mask:0xf
    v_dot2c_f32_bf16_dpp v13, v33, v152 row_newbcast:9 row_mask:0xf bank_mask:0xf
    v_dot2c_f32_bf16_dpp v14, v29, v153 row_newbcast:9 row_mask:0xf bank_mask:0xf
    v_dot2c_f32_bf16_dpp v15, v33, v153 row_newbcast:9 row_mask:0xf bank_mask:0xf
    v_dot2c_f32_bf16_dpp v16, v29, v154 row_newbcast:9 row_mask:0xf bank_mask:0xf
    v_dot2c_f32_bf16_dpp v17, v33, v154 row_newbcast:9 row_mask:0xf bank_mask:0xf
    v_dot2c_f32_bf16_dpp v18, v29, v155 row_newbcast:9 row_mask:0xf bank_mask:0xf
    v_dot2c_f32_bf16_dpp v19, v33, v155 row_newbcast:9 row_mask:0xf bank_mask:0xf
    v_dot2c_f32_bf16_dpp v12, v29, v156 row_newbcast:13 row_mask:0xf bank_mask:0xf
    v_dot2c_f32_bf16_dpp v13, v33, v156 row_newbcast:13 row_mask:0xf bank_mask:0xf
    v_dot2c_f32_bf16_dpp v14, v29, v157 row_newbcast:13 row_mask:0xf bank_mask:0xf
    v_dot2c_f32_bf16_dpp v15, v33, v157 row_newbcast:13 row_mask:0xf bank_mask:0xf
    v_dot2c_f32_bf16_dpp v16, v29, v158 row_newbcast:13 row_mask:0xf bank_mask:0xf
    v_dot2c_f32_bf16_dpp v17, v33, v158 row_newbcast:13 row_mask:0xf bank_mask:0xf
    v_dot2c_f32_bf16_dpp v18, v29, v159 row_newbcast:13 row_mask:0xf bank_mask:0xf
    v_dot2c_f32_bf16_dpp v19, v33, v159 row_newbcast:13 row_mask:0xf bank_mask:0xf
    s_cmp_le_u32 s77, 9
    s_cbranch_scc1 Lw53
    s_and_b32 s98, s97, s71
    s_add_u32 s97, s97, s68
    buffer_load_dwordx4 v[144:147], v4, s[8:11], s98 offen nt
    s_and_b32 s98, s97, s71
    s_add_u32 s97, s97, s68
    buffer_load_dwordx4 v[148:151], v4, s[8:11], s98 offen nt
    s_and_b32 s98, s97, s71
    s_add_u32 s97, s97, s68
    buffer_load_dwordx4 v[152:155], v4, s[8:11], s98 offen nt
    s_and_b32 s98, s97, s71
    s_add_u32 s97, s97, s69
    buffer_load_dwordx4 v[156:159], v4, s[8:11], s98 offen nt
Lw53:
    v_perm_b32 v230, v122, v120, s82
    v_perm_b32 v238, v122, v120, s83
    v_perm_b32 v246, v123, v121, s82
    v_perm_b32 v254, v123, v121, s83
    v_perm_b32 v231, v126, v124, s82
    v_perm_b32 v239, v126, v124, s83
    v_perm_b32 v247, v127, v125, s82
    v_perm_b32 v255, v127, v125, s83
    s_waitcnt vmcnt(12)
    s_cmp_gt_u32 s77, 8
    s_cbranch_scc1 Lw54
    s_waitcnt vmcnt(4)
Lw54:
    v_dot2c_f32_bf16_dpp v12, v29, v160 row_newbcast:2 row_mask:0xf bank_mask:0xf
    v_dot2c_f32_bf16_dpp v13, v33, v160 row_newbcast:2 row_mask:0xf bank_mask:0xf
    v_dot2c_f32_bf16_dpp v14, v29, v161 row_newbcast:2 row_mask:0xf bank_mask:0xf
    v_dot2c_f32_bf16_dpp v15, v33, v161 row_newbcast:2 row_mask:0xf bank_mask:0xf
    v_dot2c_f32_bf16_dpp v16, v29, v162 row_newbcast:2 row_mask:0xf bank_mask:0xf
    v_dot2c_f32_bf16_dpp v17, v33, v162 row_newbcast:2 row_mask:0xf bank_mask:0xf
    v_dot2c_f32_bf16_dpp v18, v29, v163 row_newbcast:2 row_mask:0xf bank_mask:0xf
    v_dot2c_f32_bf16_dpp v19, v33, v163 row_newbcast:2 row_mask:0xf bank_mask:0xf
    v_dot2c_f32_bf16_dpp v12, v29, v164 row_newbcast:6 row_mask:0xf bank_mask:0xf
    v_dot2c_f32_bf16_dpp v13, v33, v164 row_newbcast:6 row_mask:0xf bank_mask:0xf
    v_dot2c_f32_bf16_dpp v14, v29, v165 row_newbcast:6 row_mask:0xf bank_mask:0xf
    v_dot2c_f32_bf16_dpp v15, v33, v165 row_newbcast:6 row_mask:0xf bank_mask:0xf
    v_dot2c_f32_bf16_dpp v16, v29, v166 row_newbcast:6 row_mask:0xf bank_mask:0xf
    v_dot2c_f32_bf16_dpp v17, v33, v166 row_newbcast:6 row_mask:0xf bank_mask:0xf
    v_dot2c_f32_bf16_dpp v18, v29, v167 row_newbcast:6 row_mask:0xf bank_mask:0xf
    v_dot2c_f32_bf16_dpp v19, v33, v167 row_newbcast:6 row_mask:0xf bank_mask:0xf
    v_dot2c_f32_bf16_dpp v12, v29, v168 row_newbcast:10 row_mask:0xf bank_mask:0xf
    v_dot2c_f32_bf16_dpp v13, v33, v168 row_newbcast:10 row_mask:0xf bank_mask:0xf
    v_dot2c_f32_bf16_dpp v14, v29, v169 row_newbcast:10 row_mask:0xf bank_mask:0xf
    v_dot2c_f32_bf16_dpp v15, v33, v169 row_newbcast:10 row_mask:0xf bank_mask:0xf
    v_dot2c_f32_bf16_dpp v16, v29, v170 row_newbcast:10 row_mask:0xf bank_mask:0xf
    v_dot2c_f32_bf16_dpp v17, v33, v170 row_newbcast:10 row_mask:0xf bank_mask:0xf
    v_dot2c_f32_bf16_dpp v18, v29, v171 row_newbcast:10 row_mask:0xf bank_mask:0xf
    v_dot2c_f32_bf16_dpp v19, v33, v171 row_newbcast:10 row_mask:0xf bank_mask:0xf
    v_dot2c_f32_bf16_dpp v12, v29, v172 row_newbcast:14 row_mask:0xf bank_mask:0xf
    v_dot2c_f32_bf16_dpp v13, v33, v172 row_newbcast:14 row_mask:0xf bank_mask:0xf
    v_dot2c_f32_bf16_dpp v14, v29, v173 row_newbcast:14 row_mask:0xf bank_mask:0xf
    v_dot2c_f32_bf16_dpp v15, v33, v173 row_newbcast:14 row_mask:0xf bank_mask:0xf
    v_dot2c_f32_bf16_dpp v16, v29, v174 row_newbcast:14 row_mask:0xf bank_mask:0xf
    v_dot2c_f32_bf16_dpp v17, v33, v174 row_newbcast:14 row_mask:0xf bank_mask:0xf
    v_dot2c_f32_bf16_dpp v18, v29, v175 row_newbcast:14 row_mask:0xf bank_mask:0xf
    v_dot2c_f32_bf16_dpp v19, v33, v175 row_newbcast:14 row_mask:0xf bank_mask:0xf
    s_cmp_le_u32 s77, 10
    s_cbranch_scc1 Lw55
    s_and_b32 s98, s97, s71
    s_add_u32 s97, s97, s68
    buffer_load_dwordx4 v[160:163], v4, s[8:11], s98 offen nt
    s_and_b32 s98, s97, s71
    s_add_u32 s97, s97, s68
    buffer_load_dwordx4 v[164:167], v4, s[8:11], s98 offen nt
    s_and_b32 s98, s97, s71
    s_add_u32 s97, s97, s68
    buffer_load_dwordx4 v[168:171], v4, s[8:11], s98 offen nt
    s_and_b32 s98, s97, s71
    s_add_u32 s97, s97, s69
    buffer_load_dwordx4 v[172:175], v4, s[8:11], s98 offen nt
Lw55:
    s_waitcnt vmcnt(15)
    s_cmp_gt_u32 s77, 10
    s_cbranch_scc1 Lw56
    s_waitcnt vmcnt(11)
    s_cmp_gt_u32 s77, 8
    s_cbranch_scc1 Lw56
    s_waitcnt vmcnt(3)
Lw56:
    v_dot2c_f32_bf16_dpp v12, v29, v176 row_newbcast:3 row_mask:0xf bank_mask:0xf
    v_dot2c_f32_bf16_dpp v13, v33, v176 row_newbcast:3 row_mask:0xf bank_mask:0xf
    v_dot2c_f32_bf16_dpp v14, v29, v177 row_newbcast:3 row_mask:0xf bank_mask:0xf
    v_dot2c_f32_bf16_dpp v15, v33, v177 row_newbcast:3 row_mask:0xf bank_mask:0xf
    v_dot2c_f32_bf16_dpp v16, v29, v178 row_newbcast:3 row_mask:0xf bank_mask:0xf
    v_dot2c_f32_bf16_dpp v17, v33, v178 row_newbcast:3 row_mask:0xf bank_mask:0xf
    v_dot2c_f32_bf16_dpp v18, v29, v179 row_newbcast:3 row_mask:0xf bank_mask:0xf
    v_dot2c_f32_bf16_dpp v19, v33, v179 row_newbcast:3 row_mask:0xf bank_mask:0xf
    s_waitcnt vmcnt(14)
    s_cmp_gt_u32 s77, 10
    s_cbranch_scc1 Lw57
    s_waitcnt vmcnt(10)
    s_cmp_gt_u32 s77, 8
    s_cbranch_scc1 Lw57
    s_waitcnt vmcnt(2)
Lw57:
    v_dot2c_f32_bf16_dpp v12, v29, v180 row_newbcast:7 row_mask:0xf bank_mask:0xf
    v_dot2c_f32_bf16_dpp v13, v33, v180 row_newbcast:7 row_mask:0xf bank_mask:0xf
    v_dot2c_f32_bf16_dpp v14, v29, v181 row_newbcast:7 row_mask:0xf bank_mask:0xf
    v_dot2c_f32_bf16_dpp v15, v33, v181 row_newbcast:7 row_mask:0xf bank_mask:0xf
    v_dot2c_f32_bf16_dpp v16, v29, v182 row_newbcast:7 row_mask:0xf bank_mask:0xf
    v_dot2c_f32_bf16_dpp v17, v33, v182 row_newbcast:7 row_mask:0xf bank_mask:0xf
    v_dot2c_f32_bf16_dpp v18, v29, v183 row_newbcast:7 row_mask:0xf bank_mask:0xf
    v_dot2c_f32_bf16_dpp v19, v33, v183 row_newbcast:7 row_mask:0xf bank_mask:0xf
    s_waitcnt vmcnt(13)
    s_cmp_gt_u32 s77, 10
    s_cbranch_scc1 Lw58
    s_waitcnt vmcnt(9)
    s_cmp_gt_u32 s77, 8
    s_cbranch_scc1 Lw58
    s_waitcnt vmcnt(1)
Lw58:
    v_dot2c_f32_bf16_dpp v12, v29, v184 row_newbcast:11 row_mask:0xf bank_mask:0xf
    v_dot2c_f32_bf16_dpp v13, v33, v184 row_newbcast:11 row_mask:0xf bank_mask:0xf
    v_dot2c_f32_bf16_dpp v14, v29, v185 row_newbcast:11 row_mask:0xf bank_mask:0xf
    v_dot2c_f32_bf16_dpp v15, v33, v185 row_newbcast:11 row_mask:0xf bank_mask:0xf
    v_dot2c_f32_bf16_dpp v16, v29, v186 row_newbcast:11 row_mask:0xf bank_mask:0xf
    v_dot2c_f32_bf16_dpp v17, v33, v186 row_newbcast:11 row_mask:0xf bank_mask:0xf
    v_dot2c_f32_bf16_dpp v18, v29, v187 row_newbcast:11 row_mask:0xf bank_mask:0xf
    v_dot2c_f32_bf16_dpp v19, v33, v187 row_newbcast:11 row_mask:0xf bank_mask:0xf
    s_waitcnt vmcnt(12)
    s_cmp_gt_u32 s77, 10
    s_cbranch_scc1 Lw59
    s_waitcnt vmcnt(8)
    s_cmp_gt_u32 s77, 8
    s_cbranch_scc1 Lw59
    s_waitcnt vmcnt(0)
Lw59:
    v_dot2c_f32_bf16_dpp v12, v29, v188 row_newbcast:15 row_mask:0xf bank_mask:0xf
    v_dot2c_f32_bf16_dpp v13, v33, v188 row_newbcast:15 row_mask:0xf bank_mask:0xf
    v_dot2c_f32_bf16_dpp v14, v29, v189 row_newbcast:15 row_mask:0xf bank_mask:0xf
    v_dot2c_f32_bf16_dpp v15, v33, v189 row_newbcast:15 row_mask:0xf bank_mask:0xf
    v_dot2c_f32_bf16_dpp v16, v29, v190 row_newbcast:15 row_mask:0xf bank_mask:0xf
    v_dot2c_f32_bf16_dpp v17, v33, v190 row_newbcast:15 row_mask:0xf bank_mask:0xf
    v_dot2c_f32_bf16_dpp v18, v29, v191 row_newbcast:15 row_mask:0xf bank_mask:0xf
    v_dot2c_f32_bf16_dpp v19, v33, v191 row_newbcast:15 row_mask:0xf bank_mask:0xf
    s_cmp_le_u32 s77, 8
    s_cbranch_scc1 Lepi
    s_waitcnt vmcnt(8)
    s_cmp_gt_u32 s77, 10
    s_cbranch_scc1 Lw60
    s_waitcnt vmcnt(4)
Lw60:
    v_dot2c_f32_bf16_dpp v12, v30, v128 row_newbcast:0 row_mask:0xf bank_mask:0xf
    v_dot2c_f32_bf16_dpp v13, v34, v128 row_newbcast:0 row_mask:0xf bank_mask:0xf
    v_dot2c_f32_bf16_dpp v14, v30, v129 row_newbcast:0 row_mask:0xf bank_mask:0xf
    v_dot2c_f32_bf16_dpp v15, v34, v129 row_newbcast:0 row_mask:0xf bank_mask:0xf
    v_dot2c_f32_bf16_dpp v16, v30, v130 row_newbcast:0 row_mask:0xf bank_mask:0xf
    v_dot2c_f32_bf16_dpp v17, v34, v130 row_newbcast:0 row_mask:0xf bank_mask:0xf
    v_dot2c_f32_bf16_dpp v18, v30, v131 row_newbcast:0 row_mask:0xf bank_mask:0xf
    v_dot2c_f32_bf16_dpp v19, v34, v131 row_newbcast:0 row_mask:0xf bank_mask:0xf
    v_dot2c_f32_bf16_dpp v12, v30, v132 row_newbcast:4 row_mask:0xf bank_mask:0xf
    v_dot2c_f32_bf16_dpp v13, v34, v132 row_newbcast:4 row_mask:0xf bank_mask:0xf
    v_dot2c_f32_bf16_dpp v14, v30, v133 row_newbcast:4 row_mask:0xf bank_mask:0xf
    v_dot2c_f32_bf16_dpp v15, v34, v133 row_newbcast:4 row_mask:0xf bank_mask:0xf
    v_dot2c_f32_bf16_dpp v16, v30, v134 row_newbcast:4 row_mask:0xf bank_mask:0xf
    v_dot2c_f32_bf16_dpp v17, v34, v134 row_newbcast:4 row_mask:0xf bank_mask:0xf
    v_dot2c_f32_bf16_dpp v18, v30, v135 row_newbcast:4 row_mask:0xf bank_mask:0xf
    v_dot2c_f32_bf16_dpp v19, v34, v135 row_newbcast:4 row_mask:0xf bank_mask:0xf
    v_dot2c_f32_bf16_dpp v12, v30, v136 row_newbcast:8 row_mask:0xf bank_mask:0xf
    v_dot2c_f32_bf16_dpp v13, v34, v136 row_newbcast:8 row_mask:0xf bank_mask:0xf
    v_dot2c_f32_bf16_dpp v14, v30, v137 row_newbcast:8 row_mask:0xf bank_mask:0xf
    v_dot2c_f32_bf16_dpp v15, v34, v137 row_newbcast:8 row_mask:0xf bank_mask:0xf
    v_dot2c_f32_bf16_dpp v16, v30, v138 row_newbcast:8 row_mask:0xf bank_mask:0xf
    v_dot2c_f32_bf16_dpp v17, v34, v138 row_newbcast:8 row_mask:0xf bank_mask:0xf
    v_dot2c_f32_bf16_dpp v18, v30, v139 row_newbcast:8 row_mask:0xf bank_mask:0xf
    v_dot2c_f32_bf16_dpp v19, v34, v139 row_newbcast:8 row_mask:0xf bank_mask:0xf
    v_dot2c_f32_bf16_dpp v12, v30, v140 row_newbcast:12 row_mask:0xf bank_mask:0xf
    v_dot2c_f32_bf16_dpp v13, v34, v140 row_newbcast:12 row_mask:0xf bank_mask:0xf
    v_dot2c_f32_bf16_dpp v14, v30, v141 row_newbcast:12 row_mask:0xf bank_mask:0xf
    v_dot2c_f32_bf16_dpp v15, v34, v141 row_newbcast:12 row_mask:0xf bank_mask:0xf
    v_dot2c_f32_bf16_dpp v16, v30, v142 row_newbcast:12 row_mask:0xf bank_mask:0xf
    v_dot2c_f32_bf16_dpp v17, v34, v142 row_newbcast:12 row_mask:0xf bank_mask:0xf
    v_dot2c_f32_bf16_dpp v18, v30, v143 row_newbcast:12 row_mask:0xf bank_mask:0xf
    v_dot2c_f32_bf16_dpp v19, v34, v143 row_newbcast:12 row_mask:0xf bank_mask:0xf
    s_waitcnt vmcnt(7)
    s_cmp_gt_u32 s77, 10
    s_cbranch_scc1 Lw61
    s_waitcnt vmcnt(3)
Lw61:
    v_dot2c_f32_bf16_dpp v12, v30, v144 row_newbcast:1 row_mask:0xf bank_mask:0xf
    v_dot2c_f32_bf16_dpp v13, v34, v144 row_newbcast:1 row_mask:0xf bank_mask:0xf
    v_dot2c_f32_bf16_dpp v14, v30, v145 row_newbcast:1 row_mask:0xf bank_mask:0xf
    v_dot2c_f32_bf16_dpp v15, v34, v145 row_newbcast:1 row_mask:0xf bank_mask:0xf
    v_dot2c_f32_bf16_dpp v16, v30, v146 row_newbcast:1 row_mask:0xf bank_mask:0xf
    v_dot2c_f32_bf16_dpp v17, v34, v146 row_newbcast:1 row_mask:0xf bank_mask:0xf
    v_dot2c_f32_bf16_dpp v18, v30, v147 row_newbcast:1 row_mask:0xf bank_mask:0xf
    v_dot2c_f32_bf16_dpp v19, v34, v147 row_newbcast:1 row_mask:0xf bank_mask:0xf
    s_waitcnt vmcnt(6)
    s_cmp_gt_u32 s77, 10
    s_cbranch_scc1 Lw62
    s_waitcnt vmcnt(2)
Lw62:
    v_dot2c_f32_bf16_dpp v12, v30, v148 row_newbcast:5 row_mask:0xf bank_mask:0xf
    v_dot2c_f32_bf16_dpp v13, v34, v148 row_newbcast:5 row_mask:0xf bank_mask:0xf
    v_dot2c_f32_bf16_dpp v14, v30, v149 row_newbcast:5 row_mask:0xf bank_mask:0xf
    v_dot2c_f32_bf16_dpp v15, v34, v149 row_newbcast:5 row_mask:0xf bank_mask:0xf
    v_dot2c_f32_bf16_dpp v16, v30, v150 row_newbcast:5 row_mask:0xf bank_mask:0xf
    v_dot2c_f32_bf16_dpp v17, v34, v150 row_newbcast:5 row_mask:0xf bank_mask:0xf
    v_dot2c_f32_bf16_dpp v18, v30, v151 row_newbcast:5 row_mask:0xf bank_mask:0xf
    v_dot2c_f32_bf16_dpp v19, v34, v151 row_newbcast:5 row_mask:0xf bank_mask:0xf
    s_waitcnt vmcnt(5)
    s_cmp_gt_u32 s77, 10
    s_cbranch_scc1 Lw63
    s_waitcnt vmcnt(1)
Lw63:
    v_dot2c_f32_bf16_dpp v12, v30, v152 row_newbcast:9 row_mask:0xf bank_mask:0xf
    v_dot2c_f32_bf16_dpp v13, v34, v152 row_newbcast:9 row_mask:0xf bank_mask:0xf
    v_dot2c_f32_bf16_dpp v14, v30, v153 row_newbcast:9 row_mask:0xf bank_mask:0xf
    v_dot2c_f32_bf16_dpp v15, v34, v153 row_newbcast:9 row_mask:0xf bank_mask:0xf
    v_dot2c_f32_bf16_dpp v16, v30, v154 row_newbcast:9 row_mask:0xf bank_mask:0xf
    v_dot2c_f32_bf16_dpp v17, v34, v154 row_newbcast:9 row_mask:0xf bank_mask:0xf
    v_dot2c_f32_bf16_dpp v18, v30, v155 row_newbcast:9 row_mask:0xf bank_mask:0xf
    v_dot2c_f32_bf16_dpp v19, v34, v155 row_newbcast:9 row_mask:0xf bank_mask:0xf
    s_waitcnt vmcnt(4)
    s_cmp_gt_u32 s77, 10
    s_cbranch_scc1 Lw64
    s_waitcnt vmcnt(0)
Lw64:
    v_dot2c_f32_bf16_dpp v12, v30, v156 row_newbcast:13 row_mask:0xf bank_mask:0xf
    v_dot2c_f32_bf16_dpp v13, v34, v156 row_newbcast:13 row_mask:0xf bank_mask:0xf
    v_dot2c_f32_bf16_dpp v14, v30, v157 row_newbcast:13 row_mask:0xf bank_mask:0xf
    v_dot2c_f32_bf16_dpp v15, v34, v157 row_newbcast:13 row_mask:0xf bank_mask:0xf
    v_dot2c_f32_bf16_dpp v16, v30, v158 row_newbcast:13 row_mask:0xf bank_mask:0xf
    v_dot2c_f32_bf16_dpp v17, v34, v158 row_newbcast:13 row_mask:0xf bank_mask:0xf
    v_dot2c_f32_bf16_dpp v18, v30, v159 row_newbcast:13 row_mask:0xf bank_mask:0xf
    v_dot2c_f32_bf16_dpp v19, v34, v159 row_newbcast:13 row_mask:0xf bank_mask:0xf
    s_cmp_le_u32 s77, 10
    s_cbranch_scc1 Lepi
    s_waitcnt vmcnt(3)
    v_dot2c_f32_bf16_dpp v12, v30, v160 row_newbcast:2 row_mask:0xf bank_mask:0xf
    v_dot2c_f32_bf16_dpp v13, v34, v160 row_newbcast:2 row_mask:0xf bank_mask:0xf
    v_dot2c_f32_bf16_dpp v14, v30, v161 row_newbcast:2 row_mask:0xf bank_mask:0xf
    v_dot2c_f32_bf16_dpp v15, v34, v161 row_newbcast:2 row_mask:0xf bank_mask:0xf
    v_dot2c_f32_bf16_dpp v16, v30, v162 row_newbcast:2 row_mask:0xf bank_mask:0xf
    v_dot2c_f32_bf16_dpp v17, v34, v162 row_newbcast:2 row_mask:0xf bank_mask:0xf
    v_dot2c_f32_bf16_dpp v18, v30, v163 row_newbcast:2 row_mask:0xf bank_mask:0xf
    v_dot2c_f32_bf16_dpp v19, v34, v163 row_newbcast:2 row_mask:0xf bank_mask:0xf
    s_waitcnt vmcnt(2)
    v_dot2c_f32_bf16_dpp v12, v30, v164 row_newbcast:6 row_mask:0xf bank_mask:0xf
    v_dot2c_f32_bf16_dpp v13, v34, v164 row_newbcast:6 row_mask:0xf bank_mask:0xf
    v_dot2c_f32_bf16_dpp v14, v30, v165 row_newbcast:6 row_mask:0xf bank_mask:0xf
    v_dot2c_f32_bf16_dpp v15, v34, v165 row_newbcast:6 row_mask:0xf bank_mask:0xf
    v_dot2c_f32_bf16_dpp v16, v30, v166 row_newbcast:6 row_mask:0xf bank_mask:0xf
    v_dot2c_f32_bf16_dpp v17, v34, v166 row_newbcast:6 row_mask:0xf bank_mask:0xf
    v_dot2c_f32_bf16_dpp v18, v30, v167 row_newbcast:6 row_mask:0xf bank_mask:0xf
    v_dot2c_f32_bf16_dpp v19, v34, v167 row_newbcast:6 row_mask:0xf bank_mask:0xf
    s_waitcnt vmcnt(1)
    v_dot2c_f32_bf16_dpp v12, v30, v168 row_newbcast:10 row_mask:0xf bank_mask:0xf
    v_dot2c_f32_bf16_dpp v13, v34, v168 row_newbcast:10 row_mask:0xf bank_mask:0xf
    v_dot2c_f32_bf16_dpp v14, v30, v169 row_newbcast:10 row_mask:0xf bank_mask:0xf
    v_dot2c_f32_bf16_dpp v15, v34, v169 row_newbcast:10 row_mask:0xf bank_mask:0xf
    v_dot2c_f32_bf16_dpp v16, v30, v170 row_newbcast:10 row_mask:0xf bank_mask:0xf
    v_dot2c_f32_bf16_dpp v17, v34, v170 row_newbcast:10 row_mask:0xf bank_mask:0xf
    v_dot2c_f32_bf16_dpp v18, v30, v171 row_newbcast:10 row_mask:0xf bank_mask:0xf
    v_dot2c_f32_bf16_dpp v19, v34, v171 row_newbcast:10 row_mask:0xf bank_mask:0xf
    s_waitcnt vmcnt(0)
    v_dot2c_f32_bf16_dpp v12, v30, v172 row_newbcast:14 row_mask:0xf bank_mask:0xf
    v_dot2c_f32_bf16_dpp v13, v34, v172 row_newbcast:14 row_mask:0xf bank_mask:0xf
    v_dot2c_f32_bf16_dpp v14, v30, v173 row_newbcast:14 row_mask:0xf bank_mask:0xf
    v_dot2c_f32_bf16_dpp v15, v34, v173 row_newbcast:14 row_mask:0xf bank_mask:0xf
    v_dot2c_f32_bf16_dpp v16, v30, v174 row_newbcast:14 row_mask:0xf bank_mask:0xf
    v_dot2c_f32_bf16_dpp v17, v34, v174 row_newbcast:14 row_mask:0xf bank_mask:0xf
    v_dot2c_f32_bf16_dpp v18, v30, v175 row_newbcast:14 row_mask:0xf bank_mask:0xf
    v_dot2c_f32_bf16_dpp v19, v34, v175 row_newbcast:14 row_mask:0xf bank_mask:0xf
Lepi:
    s_nop 2
    v_permlane32_swap_b32 v12, v16
    v_permlane32_swap_b32 v13, v17
    v_permlane32_swap_b32 v14, v18
    v_permlane32_swap_b32 v15, v19
    v_add_f32 v12, v12, v16
    v_add_f32 v14, v14, v18
    v_add_f32 v13, v13, v17
    v_add_f32 v15, v15, v19
    s_nop 1
    v_permlane16_swap_b32 v12, v14
    v_permlane16_swap_b32 v13, v15
    v_add_f32 v12, v12, v14
    v_add_f32 v13, v13, v15
    v_cvt_pk_bf16_f32 v8, v12, v13
    ds_write_b32 v53, v8 offset:8192
    s_waitcnt lgkmcnt(0)
    s_barrier
    ds_read_b128 v[12:15], v52 offset:8192
    ds_read_b128 v[16:19], v52 offset:9216
    s_waitcnt lgkmcnt(1)
    v_smfmac_f32_16x16x64_bf16 v[36:39], v[12:15], v[192:199], v59
    v_smfmac_f32_16x16x64_bf16 v[40:43], v[12:15], v[200:207], v59
    v_smfmac_f32_16x16x64_bf16 v[44:47], v[12:15], v[208:215], v59
    v_smfmac_f32_16x16x64_bf16 v[48:51], v[12:15], v[216:223], v59
    s_waitcnt lgkmcnt(0)
    v_smfmac_f32_16x16x64_bf16 v[36:39], v[16:19], v[224:231], v59
    v_smfmac_f32_16x16x64_bf16 v[40:43], v[16:19], v[232:239], v59
    v_smfmac_f32_16x16x64_bf16 v[44:47], v[16:19], v[240:247], v59
    v_smfmac_f32_16x16x64_bf16 v[48:51], v[16:19], v[248:255], v59
    s_nop 4
    v_add_f32 v36, v36, v37
    v_add_f32 v38, v38, v39
    v_add_f32 v40, v40, v41
    v_add_f32 v42, v42, v43
    v_add_f32 v44, v44, v45
    v_add_f32 v46, v46, v47
    v_add_f32 v48, v48, v49
    v_add_f32 v50, v50, v51
    v_add_f32 v24, v36, v38
    v_add_f32 v26, v44, v46
    v_add_f32 v25, v40, v42
    v_add_f32 v27, v48, v50
    s_nop 0
    v_permlane32_swap_b32 v24, v26
    v_permlane32_swap_b32 v25, v27
    v_add_f32 v24, v24, v26
    v_add_f32 v25, v25, v27
    s_nop 1
    v_permlane16_swap_b32 v24, v25
    v_add_f32 v24, v24, v25
    v_bfi_b32 v24, 31, v0, v24
    buffer_store_dword v24, v7, s[24:27], 0 offen sc1
    s_cmp_lg_u32 s92, 1
    s_cbranch_scc1 Lfin
    buffer_load_dwordx4 v[128:131], v54, s[24:27], s91 offen sc1
    s_lshl_b32 s78, s76, 10
    v_add_u32 v36, s78, v4
    ds_read_b128 v[136:139], v36 offset:16384
    v_lshrrev_b32 v6, 2, v3
    v_and_b32 v5, 3, v3
    v_lshlrev_b32 v5, 3, v5
    s_lshl_b32 s78, s76, 8
    v_lshl_add_u32 v40, v1, 2, s78
    v_lshlrev_b32 v41, 2, v1
    v_mov_b32 v44, 0
    v_mov_b32 v45, 1
    ds_read_b64 v[46:47], v44 offset:15432
    s_lshl_b32 s78, s72, 10
    s_lshr_b32 s79, s93, 2
    s_lshl_b32 s79, s79, 7
    s_add_u32 s78, s78, s79
    s_and_b32 s79, s93, 3
    s_lshl_b32 s79, s79, 1
    s_add_u32 s78, s78, s79
    v_lshl_add_u32 v42, v3, 5, s78
    v_lshl_add_u32 v42, v2, 3, v42
    s_mov_b32 s20, 0x000f000f
    s_mov_b32 s21, 0x000f000f
    s_mov_b32 s80, 256
    s_mov_b32 s81, -32
Lpoll2:
    s_waitcnt vmcnt(0) lgkmcnt(0)
    v_bitop3_b32 v36, v128, v136, 1 bitop3:0x28
    v_bitop3_b32 v36, v129, v137, v36 bitop3:0x28
    v_bitop3_b32 v36, v130, v138, v36 bitop3:0x28
    v_bitop3_b32 v36, v131, v139, v36 bitop3:0x28
    v_cmp_eq_u32 vcc, 0, v36
    s_and_b64 exec, exec, vcc
    s_cbranch_execz Lgot
    buffer_load_dwordx4 v[128:131], v54, s[24:27], s91 offen sc1
    s_sub_u32 s80, s80, 1
    s_cbranch_scc0 Lpoll2
Lslow:
    s_mov_b64 exec, -1
    s_mov_b32 s80, 0x40000
Lslow1:
    buffer_load_dwordx4 v[128:131], v54, s[24:27], s91 offen sc1
    s_waitcnt vmcnt(0)
    v_bfe_u32 v132, v128, 3, 2
    v_bfe_u32 v133, v129, 3, 2
    v_bfe_u32 v134, v130, 3, 2
    v_bfe_u32 v135, v131, 3, 2
    v_lshl_or_b32 v132, v133, 2, v132
    v_lshl_or_b32 v134, v135, 2, v134
    v_lshl_or_b32 v132, v134, 4, v132
    v_bfe_u32 v133, v55, v5, 8
    v_cmp_ne_u32 vcc, v132, v133
    s_cbranch_vccz Lgot
    s_sleep 16
    s_sub_u32 s80, s80, 1
    s_cbranch_scc0 Lslow1
Lgot:
    s_mov_b64 exec, -1
Lgot1:
    v_bfe_u32 v132, v128, 1, 2
    v_bfe_u32 v133, v129, 1, 2
    v_bfe_u32 v134, v130, 1, 2
    v_bfe_u32 v135, v131, 1, 2
    v_lshl_or_b32 v132, v133, 2, v132
    v_lshl_or_b32 v134, v135, 2, v134
    v_lshl_or_b32 v132, v134, 4, v132
    v_lshlrev_b32 v132, v5, v132
    v_and_b32 v128, s81, v128
    v_and_b32 v129, s81, v129
    v_or_b32_dpp v132, v132, v132 quad_perm:[1,0,3,2] row_mask:0xf bank_mask:0xf
    v_and_b32 v130, s81, v130
    v_and_b32 v131, s81, v131
    v_or_b32_dpp v132, v132, v132 quad_perm:[2,3,0,1] row_mask:0xf bank_mask:0xf
    v_cmp_eq_u32 vcc, 3, v6
    s_nop 0
    v_max_f32_dpp v133, v132, v132 row_ror:8 row_mask:0xf bank_mask:0xf
    s_nop 1
    v_max_f32_dpp v133, v133, v133 row_ror:4 row_mask:0xf bank_mask:0xf
    v_sub_f32 v132, v132, v133
    v_exp_f32 v132, v132
    s_nop 1
    v_add_f32_dpp v133, v132, v132 row_ror:8 row_mask:0xf bank_mask:0xf
    s_nop 1
    v_add_f32_dpp v133, v133, v133 row_ror:4 row_mask:0xf bank_mask:0xf
    v_rcp_f32 v133, v133
    s_nop 0
    v_mul_f32 v132, v132, v133
    v_cndmask_b32 v132, v132, 1.0, vcc
    v_mul_f32 v128, v132, v128
    v_mul_f32 v130, v132, v130
    v_mul_f32 v129, v132, v129
    v_mul_f32 v131, v132, v131
    s_nop 0
    v_permlane32_swap_b32 v128, v130
    v_permlane32_swap_b32 v129, v131
    v_add_f32 v128, v128, v130
    v_add_f32 v129, v129, v131
    s_nop 0
    s_cmp_lg_u32 s76, 0
    v_permlane16_swap_b32 v128, v129
    v_add_f32 v128, v128, v129
    ds_write_b32 v40, v128 offset:12544
    s_mov_b64 exec, 1
    ds_add_rtn_u32 v45, v44, v45 offset:15360
    s_mov_b64 exec, -1
    ds_read_b32 v144, v41 offset:12544
    ds_read_b32 v145, v41 offset:12800
    ds_read_b32 v146, v41 offset:13056
    ds_read_b32 v147, v41 offset:13312
    ds_read_b32 v148, v41 offset:13568
    ds_read_b32 v149, v41 offset:13824
    ds_read_b32 v150, v41 offset:14080
    ds_read_b32 v151, v41 offset:14336
    s_waitcnt lgkmcnt(8)
    v_readfirstlane_b32 s78, v45
    s_waitcnt lgkmcnt(0)
    s_cmp_lg_u32 s78, 11
    s_cbranch_scc1 Lfin
    v_add_f32 v144, v144, v148
    v_add_f32 v145, v145, v149
    v_add_f32 v146, v146, v150
    v_add_f32 v147, v147, v151
    v_add_f32 v144, v144, v146
    v_add_f32 v145, v145, v147
    v_add_f32 v144, v144, v145
    s_nop 1
    v_add_f32_dpp v145, v144, v144 row_shl:4 row_mask:0xf bank_mask:0xf
    v_mov_b32_dpp v146, v144 row_shl:12 row_mask:0xf bank_mask:0xf
    v_mov_b32_dpp v147, v144 row_shl:8 row_mask:0xf bank_mask:0xf
    v_cvt_pk_bf16_f32 v146, 0, v146
    v_add_f32 v145, v145, v147
    v_mul_f32 v146, v47, v146
    v_cvt_pk_bf16_f32 v145, 0, v145
    v_cvt_pk_bf16_f32 v146, 0, v146
    v_mul_f32 v145, v46, v145
    s_mov_b64 exec, s[20:21]
    v_cvt_pk_bf16_f32 v145, 0, v145
    v_add_f32 v145, v145, v146
    v_cvt_pk_bf16_f32 v145, v145, 0
    buffer_store_short v145, v42, s[28:31], 0 offen
Lfin:
Lend:
    s_endpgm
Lcommon:
    s_and_b32 s98, s96, s71
    s_add_u32 s96, s96, s68
    buffer_load_dwordx4 v[80:83], v4, s[4:7], s98 offen nt
    s_and_b32 s98, s96, s71
    s_add_u32 s96, s96, s68
    buffer_load_dwordx4 v[84:87], v4, s[4:7], s98 offen nt
    s_and_b32 s98, s96, s71
    s_add_u32 s96, s96, s68
    buffer_load_dwordx4 v[88:91], v4, s[4:7], s98 offen nt
    s_and_b32 s98, s96, s71
    s_add_u32 s96, s96, s69
    buffer_load_dwordx4 v[92:95], v4, s[4:7], s98 offen nt
    s_and_b32 s98, s96, s71
    s_add_u32 s96, s96, s68
    buffer_load_dwordx4 v[96:99], v4, s[4:7], s98 offen nt
    s_and_b32 s98, s96, s71
    s_add_u32 s96, s96, s68
    buffer_load_dwordx4 v[100:103], v4, s[4:7], s98 offen nt
    s_and_b32 s98, s96, s71
    s_add_u32 s96, s96, s68
    buffer_load_dwordx4 v[104:107], v4, s[4:7], s98 offen nt
    s_and_b32 s98, s96, s71
    s_add_u32 s96, s96, s69
    s_waitcnt vmcnt(6)
    buffer_load_dwordx4 v[108:111], v4, s[4:7], s98 offen nt
    s_branch Lcommon2
Lbpro:
Lbrest:
    s_lshl_b32 s74, s72, 5
    s_add_u32 s74, s74, s70
    v_lshrrev_b32 v2, 4, v1
    v_and_b32 v3, 15, v1
    v_lshlrev_b32 v52, 5, v3
    v_lshl_add_u32 v52, v2, 3, v52
    s_mov_b32 s26, 622592
    s_mov_b32 s27, 0x20000
    s_mov_b32 s34, 256
    s_mov_b32 s35, 0x20000
    s_mov_b32 s82, 0x05040100
    s_mov_b32 s83, 0x07060302
    s_mov_b32 s85, 0x3fb8aa3b
    v_lshlrev_b32 v4, 4, v1
    s_lshl_b32 s80, s76, 8
    v_lshl_add_u32 v44, v1, 2, s80
    v_mov_b32 v36, 0
    ds_write_b32 v36, v36 offset:15360
    s_lshl_b32 s78, s70, 2
    s_add_u32 s78, s78, s72
    s_add_u32 s78, s78, 2
    s_lshl_b32 s80, s87, 1
    s_add_u32 s80, s80, s72
    s_lshl_b32 s80, s80, 1
    s_cmp_eq_u32 s76, 1
    s_cselect_b32 s78, s80, s78
    s_lshl_b32 s78, s78, 9
    s_add_u32 s78, s78, 524288
    v_lshl_add_u32 v58, v1, 3, s78
    s_lshl_b32 s79, s72, 5
    v_add_u32 v54, s79, v2
    v_lshrrev_b32 v37, 2, v3
    v_lshl_add_u32 v54, v54, 2, v37
    v_lshlrev_b32 v54, 11, v54
    v_and_b32 v38, 3, v3
    v_lshl_add_u32 v54, v38, 4, v54
    s_and_b32 s93, s70, 7
    s_lshl_b32 s93, s93, 2
    s_lshr_b32 s80, s70, 3
    s_add_u32 s93, s93, s80
    s_lshl_b32 s80, s93, 6
    v_add_u32 v54, s80, v54
    s_lshl_b32 s91, s76, 15
    s_mul_i32 s96, s76, 839680
    s_mul_i32 s78, s74, 195584
    s_add_u32 s96, s96, s78
    s_mov_b32 s97, s96
    s_mov_b32 s68, 209920
    s_mov_b32 s69, 6087680
    s_mov_b32 s71, 261120
    s_mov_b32 s6, 0x40000
    s_mov_b32 s7, 0x20000
    s_mov_b32 s10, 0x40000
    s_mov_b32 s11, 0x20000
    s_mov_b32 s92, 1
    s_mov_b32 s3, 0xff800000
    s_mov_b32 s73, 3
    s_mov_b32 s77, 8
    s_mov_b32 s22, 2048
    s_mov_b32 s23, 0x20000
    s_lshl_b32 s79, s74, 20
    s_add_u32 s79, s79, 0xc0000
    s_lshl_b32 s80, s87, 8
    s_cmp_eq_u32 s72, 1
    s_waitcnt lgkmcnt(0)
    s_cselect_b64 s[12:13], s[56:57], s[46:47]
    s_add_u32 s12, s12, s80
    s_addc_u32 s13, s13, 0
    s_mov_b64 s[20:21], s[40:41]
    s_mov_b64 s[24:25], s[66:67]
    s_mov_b64 s[32:33], s[64:65]
    s_add_u32 s4, s52, s79
    s_addc_u32 s5, s53, 0
    s_add_u32 s8, s54, s79
    s_addc_u32 s9, s55, 0
    s_cmp_lt_u32 s76, 4
    s_cbranch_scc1 Lqwork
    s_cmp_lg_u32 s2, 0
    s_cbranch_scc1 Lnononce
    s_cmp_lg_u32 s76, 4
    s_cbranch_scc1 Lnononce
    s_memrealtime s[88:89]
    s_waitcnt lgkmcnt(0)
    s_mul_i32 s78, s88, 0x9E3779B1
    s_lshr_b32 s78, s78, 2
    s_or_b32 s78, s78, 1
    v_mov_b32 v38, s78
    s_setprio 3
    s_mov_b64 exec, 1
    buffer_store_dword v38, v36, s[32:35], 0 offen sc1
    s_mov_b64 exec, -1
    s_setprio 0
Lnononce:
    s_barrier
    s_cmp_lg_u32 s76, 5
    s_cbranch_scc1 Lcommon
    buffer_load_dwordx4 v[64:67], v54, s[24:27], 0 offen sc1
    s_mov_b32 s78, 32768
    buffer_load_dwordx4 v[68:71], v54, s[24:27], s78 offen sc1
    s_mov_b32 s78, 65536
    buffer_load_dwordx4 v[72:75], v54, s[24:27], s78 offen sc1
    s_mov_b32 s78, 98304
    buffer_load_dwordx4 v[76:79], v54, s[24:27], s78 offen sc1
    s_mov_b32 s78, 131072
    buffer_load_dwordx4 v[80:83], v54, s[24:27], s78 offen sc1
    s_mov_b32 s78, 163840
    buffer_load_dwordx4 v[84:87], v54, s[24:27], s78 offen sc1
    s_mov_b32 s78, 196608
    buffer_load_dwordx4 v[88:91], v54, s[24:27], s78 offen sc1
    s_mov_b32 s78, 229376
    buffer_load_dwordx4 v[92:95], v54, s[24:27], s78 offen sc1
    s_waitcnt vmcnt(0)
    ds_write_b128 v4, v[64:67] offset:16384
    ds_write_b128 v4, v[68:71] offset:17408
    ds_write_b128 v4, v[72:75] offset:18432
    ds_write_b128 v4, v[76:79] offset:19456
    ds_write_b128 v4, v[80:83] offset:20480
    ds_write_b128 v4, v[84:87] offset:21504
    ds_write_b128 v4, v[88:91] offset:22528
    ds_write_b128 v4, v[92:95] offset:23552
    s_waitcnt lgkmcnt(0)
    s_branch Lcommon
Lqwork:
    buffer_load_dword v160, v44, s[20:23], 0 offen offset:0
    buffer_load_dword v161, v44, s[20:23], 0 offen offset:1024
    s_cmp_gt_u32 s76, 1
    s_cbranch_scc1 Lnosnap2
    buffer_load_dwordx2 v[60:61], v58, s[24:27], 0 offen sc1
    s_cmp_eq_u32 s76, 0
    s_cbranch_scc1 Lgl
    buffer_load_dwordx2 v[62:63], v58, s[24:27], 0 offen offset:512 sc1
    s_branch Lnosnap2
Lgl:
    s_mov_b64 s[36:37], s[60:61]
    s_mov_b32 s38, 1024
    s_mov_b32 s39, 0x20000
    s_lshl_b32 s78, s72, 10
    buffer_load_dwordx4 v[128:131], v4, s[20:23], s78 offen
    buffer_load_dwordx4 v[132:135], v4, s[36:39], 0 offen
Lnosnap2:
    s_add_u32 s86, s86, 0x2000
    buffer_load_dwordx4 v[96:99], v5, s[12:15], s86 offen nt
    s_add_u32 s86, s86, 0x2000
    buffer_load_dwordx4 v[100:103], v5, s[12:15], s86 offen nt
    s_add_u32 s86, s86, 0x2000
    buffer_load_dwordx4 v[104:107], v5, s[12:15], s86 offen nt
    s_add_u32 s86, s86, 0x2000
    buffer_load_dwordx4 v[108:111], v5, s[12:15], s86 offen nt
    s_add_u32 s86, s86, 0x2000
    buffer_load_dwordx4 v[112:115], v5, s[12:15], s86 offen nt
    s_add_u32 s86, s86, 0x2000
    buffer_load_dwordx4 v[116:119], v5, s[12:15], s86 offen nt
    s_add_u32 s86, s86, 0x2000
    buffer_load_dwordx4 v[120:123], v5, s[12:15], s86 offen nt
    s_add_u32 s86, s86, 0x2000
    buffer_load_dwordx4 v[124:127], v5, s[12:15], s86 offen nt
    s_add_u32 s86, s86, 0x2000
    buffer_load_dwordx4 v[192:195], v5, s[12:15], s86 offen nt
    s_add_u32 s86, s86, 0x2000
    buffer_load_dwordx4 v[196:199], v5, s[12:15], s86 offen nt
    s_add_u32 s86, s86, 0x2000
    buffer_load_dwordx4 v[200:203], v5, s[12:15], s86 offen nt
    s_add_u32 s86, s86, 0x2000
    buffer_load_dwordx4 v[204:207], v5, s[12:15], s86 offen nt
    s_barrier
    s_add_u32 s86, s86, 0x2000
    buffer_load_dwordx4 v[208:211], v5, s[12:15], s86 offen nt
    s_add_u32 s86, s86, 0x2000
    buffer_load_dwordx4 v[212:215], v5, s[12:15], s86 offen nt
    s_add_u32 s86, s86, 0x2000
    buffer_load_dwordx4 v[216:219], v5, s[12:15], s86 offen nt
    s_add_u32 s86, s86, 0x2000
    buffer_load_dwordx4 v[220:223], v5, s[12:15], s86 offen nt
    s_add_u32 s86, s86, 0x2000
    buffer_load_dwordx4 v[224:227], v5, s[12:15], s86 offen nt
    s_add_u32 s86, s86, 0x2000
    buffer_load_dwordx4 v[228:231], v5, s[12:15], s86 offen nt
    s_add_u32 s86, s86, 0x2000
    buffer_load_dwordx4 v[232:235], v5, s[12:15], s86 offen nt
    s_add_u32 s86, s86, 0x2000
    buffer_load_dwordx4 v[236:239], v5, s[12:15], s86 offen nt
    s_add_u32 s86, s86, 0x2000
    buffer_load_dwordx4 v[240:243], v5, s[12:15], s86 offen nt
    s_add_u32 s86, s86, 0x2000
    buffer_load_dwordx4 v[244:247], v5, s[12:15], s86 offen nt
    s_add_u32 s86, s86, 0x2000
    buffer_load_dwordx4 v[248:251], v5, s[12:15], s86 offen nt
    s_add_u32 s86, s86, 0x2000
    buffer_load_dwordx4 v[252:255], v5, s[12:15], s86 offen nt
    s_lshl_b32 s78, s76, 10
    v_add_u32 v53, s78, v52
    v_mov_b32 v12, 0
    v_mov_b32 v28, 0
    v_mov_b32 v13, 0
    v_mov_b32 v29, 0
    v_mov_b32 v14, 0
    v_mov_b32 v30, 0
    v_mov_b32 v15, 0
    v_mov_b32 v31, 0
    v_mov_b32 v16, 0
    v_mov_b32 v32, 0
    v_mov_b32 v17, 0
    v_mov_b32 v33, 0
    v_mov_b32 v18, 0
    v_mov_b32 v34, 0
    v_mov_b32 v19, 0
    v_mov_b32 v35, 0
    v_mov_b32 v45, 0
    s_cmp_lg_u32 s76, 1
    s_cbranch_scc1 Lnofr
    buffer_load_dword v46, v45, s[32:35], 0 offen
Lnofr:
    s_waitcnt vmcnt(24)
    v_perm_b32 v36, v68, v64, s82
    v_perm_b32 v37, v68, v64, s83
    v_perm_b32 v38, v69, v65, s82
    v_perm_b32 v39, v69, v65, s83
    v_perm_b32 v40, v70, v66, s82
    v_perm_b32 v41, v70, v66, s83
    v_perm_b32 v42, v71, v67, s82
    v_perm_b32 v43, v71, v67, s83
    v_dot2c_f32_bf16_dpp v12, v160, v36 row_newbcast:0 row_mask:0xf bank_mask:0xf
    v_dot2c_f32_bf16_dpp v13, v160, v37 row_newbcast:0 row_mask:0xf bank_mask:0xf
    v_dot2c_f32_bf16_dpp v14, v160, v38 row_newbcast:0 row_mask:0xf bank_mask:0xf
    v_dot2c_f32_bf16_dpp v15, v160, v39 row_newbcast:0 row_mask:0xf bank_mask:0xf
    v_dot2c_f32_bf16_dpp v16, v160, v40 row_newbcast:0 row_mask:0xf bank_mask:0xf
    v_dot2c_f32_bf16_dpp v17, v160, v41 row_newbcast:0 row_mask:0xf bank_mask:0xf
    v_dot2c_f32_bf16_dpp v18, v160, v42 row_newbcast:0 row_mask:0xf bank_mask:0xf
    v_dot2c_f32_bf16_dpp v19, v160, v43 row_newbcast:0 row_mask:0xf bank_mask:0xf
    v_dot2c_f32_bf16_dpp v28, v161, v36 row_newbcast:0 row_mask:0xf bank_mask:0xf
    v_dot2c_f32_bf16_dpp v29, v161, v37 row_newbcast:0 row_mask:0xf bank_mask:0xf
    v_dot2c_f32_bf16_dpp v30, v161, v38 row_newbcast:0 row_mask:0xf bank_mask:0xf
    v_dot2c_f32_bf16_dpp v31, v161, v39 row_newbcast:0 row_mask:0xf bank_mask:0xf
    v_dot2c_f32_bf16_dpp v32, v161, v40 row_newbcast:0 row_mask:0xf bank_mask:0xf
    v_dot2c_f32_bf16_dpp v33, v161, v41 row_newbcast:0 row_mask:0xf bank_mask:0xf
    v_dot2c_f32_bf16_dpp v34, v161, v42 row_newbcast:0 row_mask:0xf bank_mask:0xf
    v_dot2c_f32_bf16_dpp v35, v161, v43 row_newbcast:0 row_mask:0xf bank_mask:0xf
    v_perm_b32 v36, v76, v72, s82
    v_perm_b32 v37, v76, v72, s83
    v_perm_b32 v38, v77, v73, s82
    v_perm_b32 v39, v77, v73, s83
    v_perm_b32 v40, v78, v74, s82
    v_perm_b32 v41, v78, v74, s83
    v_perm_b32 v42, v79, v75, s82
    v_perm_b32 v43, v79, v75, s83
    v_dot2c_f32_bf16_dpp v12, v160, v36 row_newbcast:1 row_mask:0xf bank_mask:0xf
    v_dot2c_f32_bf16_dpp v13, v160, v37 row_newbcast:1 row_mask:0xf bank_mask:0xf
    v_dot2c_f32_bf16_dpp v14, v160, v38 row_newbcast:1 row_mask:0xf bank_mask:0xf
    v_dot2c_f32_bf16_dpp v15, v160, v39 row_newbcast:1 row_mask:0xf bank_mask:0xf
    v_dot2c_f32_bf16_dpp v16, v160, v40 row_newbcast:1 row_mask:0xf bank_mask:0xf
    v_dot2c_f32_bf16_dpp v17, v160, v41 row_newbcast:1 row_mask:0xf bank_mask:0xf
    v_dot2c_f32_bf16_dpp v18, v160, v42 row_newbcast:1 row_mask:0xf bank_mask:0xf
    v_dot2c_f32_bf16_dpp v19, v160, v43 row_newbcast:1 row_mask:0xf bank_mask:0xf
    v_dot2c_f32_bf16_dpp v28, v161, v36 row_newbcast:1 row_mask:0xf bank_mask:0xf
    v_dot2c_f32_bf16_dpp v29, v161, v37 row_newbcast:1 row_mask:0xf bank_mask:0xf
    v_dot2c_f32_bf16_dpp v30, v161, v38 row_newbcast:1 row_mask:0xf bank_mask:0xf
    v_dot2c_f32_bf16_dpp v31, v161, v39 row_newbcast:1 row_mask:0xf bank_mask:0xf
    v_dot2c_f32_bf16_dpp v32, v161, v40 row_newbcast:1 row_mask:0xf bank_mask:0xf
    v_dot2c_f32_bf16_dpp v33, v161, v41 row_newbcast:1 row_mask:0xf bank_mask:0xf
    v_dot2c_f32_bf16_dpp v34, v161, v42 row_newbcast:1 row_mask:0xf bank_mask:0xf
    v_dot2c_f32_bf16_dpp v35, v161, v43 row_newbcast:1 row_mask:0xf bank_mask:0xf
    v_perm_b32 v36, v84, v80, s82
    v_perm_b32 v37, v84, v80, s83
    v_perm_b32 v38, v85, v81, s82
    v_perm_b32 v39, v85, v81, s83
    v_perm_b32 v40, v86, v82, s82
    v_perm_b32 v41, v86, v82, s83
    v_perm_b32 v42, v87, v83, s82
    v_perm_b32 v43, v87, v83, s83
    v_dot2c_f32_bf16_dpp v12, v160, v36 row_newbcast:2 row_mask:0xf bank_mask:0xf
    v_dot2c_f32_bf16_dpp v13, v160, v37 row_newbcast:2 row_mask:0xf bank_mask:0xf
    v_dot2c_f32_bf16_dpp v14, v160, v38 row_newbcast:2 row_mask:0xf bank_mask:0xf
    v_dot2c_f32_bf16_dpp v15, v160, v39 row_newbcast:2 row_mask:0xf bank_mask:0xf
    v_dot2c_f32_bf16_dpp v16, v160, v40 row_newbcast:2 row_mask:0xf bank_mask:0xf
    v_dot2c_f32_bf16_dpp v17, v160, v41 row_newbcast:2 row_mask:0xf bank_mask:0xf
    v_dot2c_f32_bf16_dpp v18, v160, v42 row_newbcast:2 row_mask:0xf bank_mask:0xf
    v_dot2c_f32_bf16_dpp v19, v160, v43 row_newbcast:2 row_mask:0xf bank_mask:0xf
    v_dot2c_f32_bf16_dpp v28, v161, v36 row_newbcast:2 row_mask:0xf bank_mask:0xf
    v_dot2c_f32_bf16_dpp v29, v161, v37 row_newbcast:2 row_mask:0xf bank_mask:0xf
    v_dot2c_f32_bf16_dpp v30, v161, v38 row_newbcast:2 row_mask:0xf bank_mask:0xf
    v_dot2c_f32_bf16_dpp v31, v161, v39 row_newbcast:2 row_mask:0xf bank_mask:0xf
    v_dot2c_f32_bf16_dpp v32, v161, v40 row_newbcast:2 row_mask:0xf bank_mask:0xf
    v_dot2c_f32_bf16_dpp v33, v161, v41 row_newbcast:2 row_mask:0xf bank_mask:0xf
    v_dot2c_f32_bf16_dpp v34, v161, v42 row_newbcast:2 row_mask:0xf bank_mask:0xf
    v_dot2c_f32_bf16_dpp v35, v161, v43 row_newbcast:2 row_mask:0xf bank_mask:0xf
    v_perm_b32 v36, v92, v88, s82
    v_perm_b32 v37, v92, v88, s83
    v_perm_b32 v38, v93, v89, s82
    v_perm_b32 v39, v93, v89, s83
    v_perm_b32 v40, v94, v90, s82
    v_perm_b32 v41, v94, v90, s83
    v_perm_b32 v42, v95, v91, s82
    v_perm_b32 v43, v95, v91, s83
    v_dot2c_f32_bf16_dpp v12, v160, v36 row_newbcast:3 row_mask:0xf bank_mask:0xf
    v_dot2c_f32_bf16_dpp v13, v160, v37 row_newbcast:3 row_mask:0xf bank_mask:0xf
    v_dot2c_f32_bf16_dpp v14, v160, v38 row_newbcast:3 row_mask:0xf bank_mask:0xf
    v_dot2c_f32_bf16_dpp v15, v160, v39 row_newbcast:3 row_mask:0xf bank_mask:0xf
    v_dot2c_f32_bf16_dpp v16, v160, v40 row_newbcast:3 row_mask:0xf bank_mask:0xf
    v_dot2c_f32_bf16_dpp v17, v160, v41 row_newbcast:3 row_mask:0xf bank_mask:0xf
    v_dot2c_f32_bf16_dpp v18, v160, v42 row_newbcast:3 row_mask:0xf bank_mask:0xf
    v_dot2c_f32_bf16_dpp v19, v160, v43 row_newbcast:3 row_mask:0xf bank_mask:0xf
    v_dot2c_f32_bf16_dpp v28, v161, v36 row_newbcast:3 row_mask:0xf bank_mask:0xf
    v_dot2c_f32_bf16_dpp v29, v161, v37 row_newbcast:3 row_mask:0xf bank_mask:0xf
    v_dot2c_f32_bf16_dpp v30, v161, v38 row_newbcast:3 row_mask:0xf bank_mask:0xf
    v_dot2c_f32_bf16_dpp v31, v161, v39 row_newbcast:3 row_mask:0xf bank_mask:0xf
    v_dot2c_f32_bf16_dpp v32, v161, v40 row_newbcast:3 row_mask:0xf bank_mask:0xf
    v_dot2c_f32_bf16_dpp v33, v161, v41 row_newbcast:3 row_mask:0xf bank_mask:0xf
    v_dot2c_f32_bf16_dpp v34, v161, v42 row_newbcast:3 row_mask:0xf bank_mask:0xf
    v_dot2c_f32_bf16_dpp v35, v161, v43 row_newbcast:3 row_mask:0xf bank_mask:0xf
    s_waitcnt vmcnt(22)
    v_perm_b32 v36, v100, v96, s82
    v_perm_b32 v37, v100, v96, s83
    v_perm_b32 v38, v101, v97, s82
    v_perm_b32 v39, v101, v97, s83
    v_perm_b32 v40, v102, v98, s82
    v_perm_b32 v41, v102, v98, s83
    v_perm_b32 v42, v103, v99, s82
    v_perm_b32 v43, v103, v99, s83
    v_dot2c_f32_bf16_dpp v12, v160, v36 row_newbcast:4 row_mask:0xf bank_mask:0xf
    v_dot2c_f32_bf16_dpp v13, v160, v37 row_newbcast:4 row_mask:0xf bank_mask:0xf
    v_dot2c_f32_bf16_dpp v14, v160, v38 row_newbcast:4 row_mask:0xf bank_mask:0xf
    v_dot2c_f32_bf16_dpp v15, v160, v39 row_newbcast:4 row_mask:0xf bank_mask:0xf
    v_dot2c_f32_bf16_dpp v16, v160, v40 row_newbcast:4 row_mask:0xf bank_mask:0xf
    v_dot2c_f32_bf16_dpp v17, v160, v41 row_newbcast:4 row_mask:0xf bank_mask:0xf
    v_dot2c_f32_bf16_dpp v18, v160, v42 row_newbcast:4 row_mask:0xf bank_mask:0xf
    v_dot2c_f32_bf16_dpp v19, v160, v43 row_newbcast:4 row_mask:0xf bank_mask:0xf
    v_dot2c_f32_bf16_dpp v28, v161, v36 row_newbcast:4 row_mask:0xf bank_mask:0xf
    v_dot2c_f32_bf16_dpp v29, v161, v37 row_newbcast:4 row_mask:0xf bank_mask:0xf
    v_dot2c_f32_bf16_dpp v30, v161, v38 row_newbcast:4 row_mask:0xf bank_mask:0xf
    v_dot2c_f32_bf16_dpp v31, v161, v39 row_newbcast:4 row_mask:0xf bank_mask:0xf
    v_dot2c_f32_bf16_dpp v32, v161, v40 row_newbcast:4 row_mask:0xf bank_mask:0xf
    v_dot2c_f32_bf16_dpp v33, v161, v41 row_newbcast:4 row_mask:0xf bank_mask:0xf
    v_dot2c_f32_bf16_dpp v34, v161, v42 row_newbcast:4 row_mask:0xf bank_mask:0xf
    v_dot2c_f32_bf16_dpp v35, v161, v43 row_newbcast:4 row_mask:0xf bank_mask:0xf
    s_waitcnt vmcnt(20)
    v_perm_b32 v36, v108, v104, s82
    v_perm_b32 v37, v108, v104, s83
    v_perm_b32 v38, v109, v105, s82
    v_perm_b32 v39, v109, v105, s83
    v_perm_b32 v40, v110, v106, s82
    v_perm_b32 v41, v110, v106, s83
    v_perm_b32 v42, v111, v107, s82
    v_perm_b32 v43, v111, v107, s83
    v_dot2c_f32_bf16_dpp v12, v160, v36 row_newbcast:5 row_mask:0xf bank_mask:0xf
    v_dot2c_f32_bf16_dpp v13, v160, v37 row_newbcast:5 row_mask:0xf bank_mask:0xf
    v_dot2c_f32_bf16_dpp v14, v160, v38 row_newbcast:5 row_mask:0xf bank_mask:0xf
    v_dot2c_f32_bf16_dpp v15, v160, v39 row_newbcast:5 row_mask:0xf bank_mask:0xf
    v_dot2c_f32_bf16_dpp v16, v160, v40 row_newbcast:5 row_mask:0xf bank_mask:0xf
    v_dot2c_f32_bf16_dpp v17, v160, v41 row_newbcast:5 row_mask:0xf bank_mask:0xf
    v_dot2c_f32_bf16_dpp v18, v160, v42 row_newbcast:5 row_mask:0xf bank_mask:0xf
    v_dot2c_f32_bf16_dpp v19, v160, v43 row_newbcast:5 row_mask:0xf bank_mask:0xf
    v_dot2c_f32_bf16_dpp v28, v161, v36 row_newbcast:5 row_mask:0xf bank_mask:0xf
    v_dot2c_f32_bf16_dpp v29, v161, v37 row_newbcast:5 row_mask:0xf bank_mask:0xf
    v_dot2c_f32_bf16_dpp v30, v161, v38 row_newbcast:5 row_mask:0xf bank_mask:0xf
    v_dot2c_f32_bf16_dpp v31, v161, v39 row_newbcast:5 row_mask:0xf bank_mask:0xf
    v_dot2c_f32_bf16_dpp v32, v161, v40 row_newbcast:5 row_mask:0xf bank_mask:0xf
    v_dot2c_f32_bf16_dpp v33, v161, v41 row_newbcast:5 row_mask:0xf bank_mask:0xf
    v_dot2c_f32_bf16_dpp v34, v161, v42 row_newbcast:5 row_mask:0xf bank_mask:0xf
    v_dot2c_f32_bf16_dpp v35, v161, v43 row_newbcast:5 row_mask:0xf bank_mask:0xf
    s_waitcnt vmcnt(18)
    v_perm_b32 v36, v116, v112, s82
    v_perm_b32 v37, v116, v112, s83
    v_perm_b32 v38, v117, v113, s82
    v_perm_b32 v39, v117, v113, s83
    v_perm_b32 v40, v118, v114, s82
    v_perm_b32 v41, v118, v114, s83
    v_perm_b32 v42, v119, v115, s82
    v_perm_b32 v43, v119, v115, s83
    v_dot2c_f32_bf16_dpp v12, v160, v36 row_newbcast:6 row_mask:0xf bank_mask:0xf
    v_dot2c_f32_bf16_dpp v13, v160, v37 row_newbcast:6 row_mask:0xf bank_mask:0xf
    v_dot2c_f32_bf16_dpp v14, v160, v38 row_newbcast:6 row_mask:0xf bank_mask:0xf
    v_dot2c_f32_bf16_dpp v15, v160, v39 row_newbcast:6 row_mask:0xf bank_mask:0xf
    v_dot2c_f32_bf16_dpp v16, v160, v40 row_newbcast:6 row_mask:0xf bank_mask:0xf
    v_dot2c_f32_bf16_dpp v17, v160, v41 row_newbcast:6 row_mask:0xf bank_mask:0xf
    v_dot2c_f32_bf16_dpp v18, v160, v42 row_newbcast:6 row_mask:0xf bank_mask:0xf
    v_dot2c_f32_bf16_dpp v19, v160, v43 row_newbcast:6 row_mask:0xf bank_mask:0xf
    v_dot2c_f32_bf16_dpp v28, v161, v36 row_newbcast:6 row_mask:0xf bank_mask:0xf
    v_dot2c_f32_bf16_dpp v29, v161, v37 row_newbcast:6 row_mask:0xf bank_mask:0xf
    v_dot2c_f32_bf16_dpp v30, v161, v38 row_newbcast:6 row_mask:0xf bank_mask:0xf
    v_dot2c_f32_bf16_dpp v31, v161, v39 row_newbcast:6 row_mask:0xf bank_mask:0xf
    v_dot2c_f32_bf16_dpp v32, v161, v40 row_newbcast:6 row_mask:0xf bank_mask:0xf
    v_dot2c_f32_bf16_dpp v33, v161, v41 row_newbcast:6 row_mask:0xf bank_mask:0xf
    v_dot2c_f32_bf16_dpp v34, v161, v42 row_newbcast:6 row_mask:0xf bank_mask:0xf
    v_dot2c_f32_bf16_dpp v35, v161, v43 row_newbcast:6 row_mask:0xf bank_mask:0xf
    s_waitcnt vmcnt(16)
    v_perm_b32 v36, v124, v120, s82
    v_perm_b32 v37, v124, v120, s83
    v_perm_b32 v38, v125, v121, s82
    v_perm_b32 v39, v125, v121, s83
    v_perm_b32 v40, v126, v122, s82
    v_perm_b32 v41, v126, v122, s83
    v_perm_b32 v42, v127, v123, s82
    v_perm_b32 v43, v127, v123, s83
    v_dot2c_f32_bf16_dpp v12, v160, v36 row_newbcast:7 row_mask:0xf bank_mask:0xf
    v_dot2c_f32_bf16_dpp v13, v160, v37 row_newbcast:7 row_mask:0xf bank_mask:0xf
    v_dot2c_f32_bf16_dpp v14, v160, v38 row_newbcast:7 row_mask:0xf bank_mask:0xf
    v_dot2c_f32_bf16_dpp v15, v160, v39 row_newbcast:7 row_mask:0xf bank_mask:0xf
    v_dot2c_f32_bf16_dpp v16, v160, v40 row_newbcast:7 row_mask:0xf bank_mask:0xf
    v_dot2c_f32_bf16_dpp v17, v160, v41 row_newbcast:7 row_mask:0xf bank_mask:0xf
    v_dot2c_f32_bf16_dpp v18, v160, v42 row_newbcast:7 row_mask:0xf bank_mask:0xf
    v_dot2c_f32_bf16_dpp v19, v160, v43 row_newbcast:7 row_mask:0xf bank_mask:0xf
    v_dot2c_f32_bf16_dpp v28, v161, v36 row_newbcast:7 row_mask:0xf bank_mask:0xf
    v_dot2c_f32_bf16_dpp v29, v161, v37 row_newbcast:7 row_mask:0xf bank_mask:0xf
    v_dot2c_f32_bf16_dpp v30, v161, v38 row_newbcast:7 row_mask:0xf bank_mask:0xf
    v_dot2c_f32_bf16_dpp v31, v161, v39 row_newbcast:7 row_mask:0xf bank_mask:0xf
    v_dot2c_f32_bf16_dpp v32, v161, v40 row_newbcast:7 row_mask:0xf bank_mask:0xf
    v_dot2c_f32_bf16_dpp v33, v161, v41 row_newbcast:7 row_mask:0xf bank_mask:0xf
    v_dot2c_f32_bf16_dpp v34, v161, v42 row_newbcast:7 row_mask:0xf bank_mask:0xf
    v_dot2c_f32_bf16_dpp v35, v161, v43 row_newbcast:7 row_mask:0xf bank_mask:0xf
    s_waitcnt vmcnt(14)
    v_perm_b32 v36, v196, v192, s82
    v_perm_b32 v37, v196, v192, s83
    v_perm_b32 v38, v197, v193, s82
    v_perm_b32 v39, v197, v193, s83
    v_perm_b32 v40, v198, v194, s82
    v_perm_b32 v41, v198, v194, s83
    v_perm_b32 v42, v199, v195, s82
    v_perm_b32 v43, v199, v195, s83
    v_dot2c_f32_bf16_dpp v12, v160, v36 row_newbcast:8 row_mask:0xf bank_mask:0xf
    v_dot2c_f32_bf16_dpp v13, v160, v37 row_newbcast:8 row_mask:0xf bank_mask:0xf
    v_dot2c_f32_bf16_dpp v14, v160, v38 row_newbcast:8 row_mask:0xf bank_mask:0xf
    v_dot2c_f32_bf16_dpp v15, v160, v39 row_newbcast:8 row_mask:0xf bank_mask:0xf
    v_dot2c_f32_bf16_dpp v16, v160, v40 row_newbcast:8 row_mask:0xf bank_mask:0xf
    v_dot2c_f32_bf16_dpp v17, v160, v41 row_newbcast:8 row_mask:0xf bank_mask:0xf
    v_dot2c_f32_bf16_dpp v18, v160, v42 row_newbcast:8 row_mask:0xf bank_mask:0xf
    v_dot2c_f32_bf16_dpp v19, v160, v43 row_newbcast:8 row_mask:0xf bank_mask:0xf
    v_dot2c_f32_bf16_dpp v28, v161, v36 row_newbcast:8 row_mask:0xf bank_mask:0xf
    v_dot2c_f32_bf16_dpp v29, v161, v37 row_newbcast:8 row_mask:0xf bank_mask:0xf
    v_dot2c_f32_bf16_dpp v30, v161, v38 row_newbcast:8 row_mask:0xf bank_mask:0xf
    v_dot2c_f32_bf16_dpp v31, v161, v39 row_newbcast:8 row_mask:0xf bank_mask:0xf
    v_dot2c_f32_bf16_dpp v32, v161, v40 row_newbcast:8 row_mask:0xf bank_mask:0xf
    v_dot2c_f32_bf16_dpp v33, v161, v41 row_newbcast:8 row_mask:0xf bank_mask:0xf
    v_dot2c_f32_bf16_dpp v34, v161, v42 row_newbcast:8 row_mask:0xf bank_mask:0xf
    v_dot2c_f32_bf16_dpp v35, v161, v43 row_newbcast:8 row_mask:0xf bank_mask:0xf
    s_waitcnt vmcnt(12)
    v_perm_b32 v36, v204, v200, s82
    v_perm_b32 v37, v204, v200, s83
    v_perm_b32 v38, v205, v201, s82
    v_perm_b32 v39, v205, v201, s83
    v_perm_b32 v40, v206, v202, s82
    v_perm_b32 v41, v206, v202, s83
    v_perm_b32 v42, v207, v203, s82
    v_perm_b32 v43, v207, v203, s83
    v_dot2c_f32_bf16_dpp v12, v160, v36 row_newbcast:9 row_mask:0xf bank_mask:0xf
    v_dot2c_f32_bf16_dpp v13, v160, v37 row_newbcast:9 row_mask:0xf bank_mask:0xf
    v_dot2c_f32_bf16_dpp v14, v160, v38 row_newbcast:9 row_mask:0xf bank_mask:0xf
    v_dot2c_f32_bf16_dpp v15, v160, v39 row_newbcast:9 row_mask:0xf bank_mask:0xf
    v_dot2c_f32_bf16_dpp v16, v160, v40 row_newbcast:9 row_mask:0xf bank_mask:0xf
    v_dot2c_f32_bf16_dpp v17, v160, v41 row_newbcast:9 row_mask:0xf bank_mask:0xf
    v_dot2c_f32_bf16_dpp v18, v160, v42 row_newbcast:9 row_mask:0xf bank_mask:0xf
    v_dot2c_f32_bf16_dpp v19, v160, v43 row_newbcast:9 row_mask:0xf bank_mask:0xf
    v_dot2c_f32_bf16_dpp v28, v161, v36 row_newbcast:9 row_mask:0xf bank_mask:0xf
    v_dot2c_f32_bf16_dpp v29, v161, v37 row_newbcast:9 row_mask:0xf bank_mask:0xf
    v_dot2c_f32_bf16_dpp v30, v161, v38 row_newbcast:9 row_mask:0xf bank_mask:0xf
    v_dot2c_f32_bf16_dpp v31, v161, v39 row_newbcast:9 row_mask:0xf bank_mask:0xf
    v_dot2c_f32_bf16_dpp v32, v161, v40 row_newbcast:9 row_mask:0xf bank_mask:0xf
    v_dot2c_f32_bf16_dpp v33, v161, v41 row_newbcast:9 row_mask:0xf bank_mask:0xf
    v_dot2c_f32_bf16_dpp v34, v161, v42 row_newbcast:9 row_mask:0xf bank_mask:0xf
    v_dot2c_f32_bf16_dpp v35, v161, v43 row_newbcast:9 row_mask:0xf bank_mask:0xf
    s_waitcnt vmcnt(10)
    v_perm_b32 v36, v212, v208, s82
    v_perm_b32 v37, v212, v208, s83
    v_perm_b32 v38, v213, v209, s82
    v_perm_b32 v39, v213, v209, s83
    v_perm_b32 v40, v214, v210, s82
    v_perm_b32 v41, v214, v210, s83
    v_perm_b32 v42, v215, v211, s82
    v_perm_b32 v43, v215, v211, s83
    v_dot2c_f32_bf16_dpp v12, v160, v36 row_newbcast:10 row_mask:0xf bank_mask:0xf
    v_dot2c_f32_bf16_dpp v13, v160, v37 row_newbcast:10 row_mask:0xf bank_mask:0xf
    v_dot2c_f32_bf16_dpp v14, v160, v38 row_newbcast:10 row_mask:0xf bank_mask:0xf
    v_dot2c_f32_bf16_dpp v15, v160, v39 row_newbcast:10 row_mask:0xf bank_mask:0xf
    v_dot2c_f32_bf16_dpp v16, v160, v40 row_newbcast:10 row_mask:0xf bank_mask:0xf
    v_dot2c_f32_bf16_dpp v17, v160, v41 row_newbcast:10 row_mask:0xf bank_mask:0xf
    v_dot2c_f32_bf16_dpp v18, v160, v42 row_newbcast:10 row_mask:0xf bank_mask:0xf
    v_dot2c_f32_bf16_dpp v19, v160, v43 row_newbcast:10 row_mask:0xf bank_mask:0xf
    v_dot2c_f32_bf16_dpp v28, v161, v36 row_newbcast:10 row_mask:0xf bank_mask:0xf
    v_dot2c_f32_bf16_dpp v29, v161, v37 row_newbcast:10 row_mask:0xf bank_mask:0xf
    v_dot2c_f32_bf16_dpp v30, v161, v38 row_newbcast:10 row_mask:0xf bank_mask:0xf
    v_dot2c_f32_bf16_dpp v31, v161, v39 row_newbcast:10 row_mask:0xf bank_mask:0xf
    v_dot2c_f32_bf16_dpp v32, v161, v40 row_newbcast:10 row_mask:0xf bank_mask:0xf
    v_dot2c_f32_bf16_dpp v33, v161, v41 row_newbcast:10 row_mask:0xf bank_mask:0xf
    v_dot2c_f32_bf16_dpp v34, v161, v42 row_newbcast:10 row_mask:0xf bank_mask:0xf
    v_dot2c_f32_bf16_dpp v35, v161, v43 row_newbcast:10 row_mask:0xf bank_mask:0xf
    s_waitcnt vmcnt(8)
    v_perm_b32 v36, v220, v216, s82
    v_perm_b32 v37, v220, v216, s83
    v_perm_b32 v38, v221, v217, s82
    v_perm_b32 v39, v221, v217, s83
    v_perm_b32 v40, v222, v218, s82
    v_perm_b32 v41, v222, v218, s83
    v_perm_b32 v42, v223, v219, s82
    v_perm_b32 v43, v223, v219, s83
    v_dot2c_f32_bf16_dpp v12, v160, v36 row_newbcast:11 row_mask:0xf bank_mask:0xf
    v_dot2c_f32_bf16_dpp v13, v160, v37 row_newbcast:11 row_mask:0xf bank_mask:0xf
    v_dot2c_f32_bf16_dpp v14, v160, v38 row_newbcast:11 row_mask:0xf bank_mask:0xf
    v_dot2c_f32_bf16_dpp v15, v160, v39 row_newbcast:11 row_mask:0xf bank_mask:0xf
    v_dot2c_f32_bf16_dpp v16, v160, v40 row_newbcast:11 row_mask:0xf bank_mask:0xf
    v_dot2c_f32_bf16_dpp v17, v160, v41 row_newbcast:11 row_mask:0xf bank_mask:0xf
    v_dot2c_f32_bf16_dpp v18, v160, v42 row_newbcast:11 row_mask:0xf bank_mask:0xf
    v_dot2c_f32_bf16_dpp v19, v160, v43 row_newbcast:11 row_mask:0xf bank_mask:0xf
    v_dot2c_f32_bf16_dpp v28, v161, v36 row_newbcast:11 row_mask:0xf bank_mask:0xf
    v_dot2c_f32_bf16_dpp v29, v161, v37 row_newbcast:11 row_mask:0xf bank_mask:0xf
    v_dot2c_f32_bf16_dpp v30, v161, v38 row_newbcast:11 row_mask:0xf bank_mask:0xf
    v_dot2c_f32_bf16_dpp v31, v161, v39 row_newbcast:11 row_mask:0xf bank_mask:0xf
    v_dot2c_f32_bf16_dpp v32, v161, v40 row_newbcast:11 row_mask:0xf bank_mask:0xf
    v_dot2c_f32_bf16_dpp v33, v161, v41 row_newbcast:11 row_mask:0xf bank_mask:0xf
    v_dot2c_f32_bf16_dpp v34, v161, v42 row_newbcast:11 row_mask:0xf bank_mask:0xf
    v_dot2c_f32_bf16_dpp v35, v161, v43 row_newbcast:11 row_mask:0xf bank_mask:0xf
    s_waitcnt vmcnt(6)
    v_perm_b32 v36, v228, v224, s82
    v_perm_b32 v37, v228, v224, s83
    v_perm_b32 v38, v229, v225, s82
    v_perm_b32 v39, v229, v225, s83
    v_perm_b32 v40, v230, v226, s82
    v_perm_b32 v41, v230, v226, s83
    v_perm_b32 v42, v231, v227, s82
    v_perm_b32 v43, v231, v227, s83
    v_dot2c_f32_bf16_dpp v12, v160, v36 row_newbcast:12 row_mask:0xf bank_mask:0xf
    v_dot2c_f32_bf16_dpp v13, v160, v37 row_newbcast:12 row_mask:0xf bank_mask:0xf
    v_dot2c_f32_bf16_dpp v14, v160, v38 row_newbcast:12 row_mask:0xf bank_mask:0xf
    v_dot2c_f32_bf16_dpp v15, v160, v39 row_newbcast:12 row_mask:0xf bank_mask:0xf
    v_dot2c_f32_bf16_dpp v16, v160, v40 row_newbcast:12 row_mask:0xf bank_mask:0xf
    v_dot2c_f32_bf16_dpp v17, v160, v41 row_newbcast:12 row_mask:0xf bank_mask:0xf
    v_dot2c_f32_bf16_dpp v18, v160, v42 row_newbcast:12 row_mask:0xf bank_mask:0xf
    v_dot2c_f32_bf16_dpp v19, v160, v43 row_newbcast:12 row_mask:0xf bank_mask:0xf
    v_dot2c_f32_bf16_dpp v28, v161, v36 row_newbcast:12 row_mask:0xf bank_mask:0xf
    v_dot2c_f32_bf16_dpp v29, v161, v37 row_newbcast:12 row_mask:0xf bank_mask:0xf
    v_dot2c_f32_bf16_dpp v30, v161, v38 row_newbcast:12 row_mask:0xf bank_mask:0xf
    v_dot2c_f32_bf16_dpp v31, v161, v39 row_newbcast:12 row_mask:0xf bank_mask:0xf
    v_dot2c_f32_bf16_dpp v32, v161, v40 row_newbcast:12 row_mask:0xf bank_mask:0xf
    v_dot2c_f32_bf16_dpp v33, v161, v41 row_newbcast:12 row_mask:0xf bank_mask:0xf
    v_dot2c_f32_bf16_dpp v34, v161, v42 row_newbcast:12 row_mask:0xf bank_mask:0xf
    v_dot2c_f32_bf16_dpp v35, v161, v43 row_newbcast:12 row_mask:0xf bank_mask:0xf
    s_waitcnt vmcnt(4)
    v_perm_b32 v36, v236, v232, s82
    v_perm_b32 v37, v236, v232, s83
    v_perm_b32 v38, v237, v233, s82
    v_perm_b32 v39, v237, v233, s83
    v_perm_b32 v40, v238, v234, s82
    v_perm_b32 v41, v238, v234, s83
    v_perm_b32 v42, v239, v235, s82
    v_perm_b32 v43, v239, v235, s83
    v_dot2c_f32_bf16_dpp v12, v160, v36 row_newbcast:13 row_mask:0xf bank_mask:0xf
    v_dot2c_f32_bf16_dpp v13, v160, v37 row_newbcast:13 row_mask:0xf bank_mask:0xf
    v_dot2c_f32_bf16_dpp v14, v160, v38 row_newbcast:13 row_mask:0xf bank_mask:0xf
    v_dot2c_f32_bf16_dpp v15, v160, v39 row_newbcast:13 row_mask:0xf bank_mask:0xf
    v_dot2c_f32_bf16_dpp v16, v160, v40 row_newbcast:13 row_mask:0xf bank_mask:0xf
    v_dot2c_f32_bf16_dpp v17, v160, v41 row_newbcast:13 row_mask:0xf bank_mask:0xf
    v_dot2c_f32_bf16_dpp v18, v160, v42 row_newbcast:13 row_mask:0xf bank_mask:0xf
    v_dot2c_f32_bf16_dpp v19, v160, v43 row_newbcast:13 row_mask:0xf bank_mask:0xf
    v_dot2c_f32_bf16_dpp v28, v161, v36 row_newbcast:13 row_mask:0xf bank_mask:0xf
    v_dot2c_f32_bf16_dpp v29, v161, v37 row_newbcast:13 row_mask:0xf bank_mask:0xf
    v_dot2c_f32_bf16_dpp v30, v161, v38 row_newbcast:13 row_mask:0xf bank_mask:0xf
    v_dot2c_f32_bf16_dpp v31, v161, v39 row_newbcast:13 row_mask:0xf bank_mask:0xf
    v_dot2c_f32_bf16_dpp v32, v161, v40 row_newbcast:13 row_mask:0xf bank_mask:0xf
    v_dot2c_f32_bf16_dpp v33, v161, v41 row_newbcast:13 row_mask:0xf bank_mask:0xf
    v_dot2c_f32_bf16_dpp v34, v161, v42 row_newbcast:13 row_mask:0xf bank_mask:0xf
    v_dot2c_f32_bf16_dpp v35, v161, v43 row_newbcast:13 row_mask:0xf bank_mask:0xf
    s_waitcnt vmcnt(2)
    v_perm_b32 v36, v244, v240, s82
    v_perm_b32 v37, v244, v240, s83
    v_perm_b32 v38, v245, v241, s82
    v_perm_b32 v39, v245, v241, s83
    v_perm_b32 v40, v246, v242, s82
    v_perm_b32 v41, v246, v242, s83
    v_perm_b32 v42, v247, v243, s82
    v_perm_b32 v43, v247, v243, s83
    v_dot2c_f32_bf16_dpp v12, v160, v36 row_newbcast:14 row_mask:0xf bank_mask:0xf
    v_dot2c_f32_bf16_dpp v13, v160, v37 row_newbcast:14 row_mask:0xf bank_mask:0xf
    v_dot2c_f32_bf16_dpp v14, v160, v38 row_newbcast:14 row_mask:0xf bank_mask:0xf
    v_dot2c_f32_bf16_dpp v15, v160, v39 row_newbcast:14 row_mask:0xf bank_mask:0xf
    v_dot2c_f32_bf16_dpp v16, v160, v40 row_newbcast:14 row_mask:0xf bank_mask:0xf
    v_dot2c_f32_bf16_dpp v17, v160, v41 row_newbcast:14 row_mask:0xf bank_mask:0xf
    v_dot2c_f32_bf16_dpp v18, v160, v42 row_newbcast:14 row_mask:0xf bank_mask:0xf
    v_dot2c_f32_bf16_dpp v19, v160, v43 row_newbcast:14 row_mask:0xf bank_mask:0xf
    v_dot2c_f32_bf16_dpp v28, v161, v36 row_newbcast:14 row_mask:0xf bank_mask:0xf
    v_dot2c_f32_bf16_dpp v29, v161, v37 row_newbcast:14 row_mask:0xf bank_mask:0xf
    v_dot2c_f32_bf16_dpp v30, v161, v38 row_newbcast:14 row_mask:0xf bank_mask:0xf
    v_dot2c_f32_bf16_dpp v31, v161, v39 row_newbcast:14 row_mask:0xf bank_mask:0xf
    v_dot2c_f32_bf16_dpp v32, v161, v40 row_newbcast:14 row_mask:0xf bank_mask:0xf
    v_dot2c_f32_bf16_dpp v33, v161, v41 row_newbcast:14 row_mask:0xf bank_mask:0xf
    v_dot2c_f32_bf16_dpp v34, v161, v42 row_newbcast:14 row_mask:0xf bank_mask:0xf
    v_dot2c_f32_bf16_dpp v35, v161, v43 row_newbcast:14 row_mask:0xf bank_mask:0xf
    s_waitcnt vmcnt(0)
    v_perm_b32 v36, v252, v248, s82
    v_perm_b32 v37, v252, v248, s83
    v_perm_b32 v38, v253, v249, s82
    v_perm_b32 v39, v253, v249, s83
    v_perm_b32 v40, v254, v250, s82
    v_perm_b32 v41, v254, v250, s83
    v_perm_b32 v42, v255, v251, s82
    v_perm_b32 v43, v255, v251, s83
    v_dot2c_f32_bf16_dpp v12, v160, v36 row_newbcast:15 row_mask:0xf bank_mask:0xf
    v_dot2c_f32_bf16_dpp v13, v160, v37 row_newbcast:15 row_mask:0xf bank_mask:0xf
    v_dot2c_f32_bf16_dpp v14, v160, v38 row_newbcast:15 row_mask:0xf bank_mask:0xf
    v_dot2c_f32_bf16_dpp v15, v160, v39 row_newbcast:15 row_mask:0xf bank_mask:0xf
    v_dot2c_f32_bf16_dpp v16, v160, v40 row_newbcast:15 row_mask:0xf bank_mask:0xf
    v_dot2c_f32_bf16_dpp v17, v160, v41 row_newbcast:15 row_mask:0xf bank_mask:0xf
    v_dot2c_f32_bf16_dpp v18, v160, v42 row_newbcast:15 row_mask:0xf bank_mask:0xf
    v_dot2c_f32_bf16_dpp v19, v160, v43 row_newbcast:15 row_mask:0xf bank_mask:0xf
    v_dot2c_f32_bf16_dpp v28, v161, v36 row_newbcast:15 row_mask:0xf bank_mask:0xf
    v_dot2c_f32_bf16_dpp v29, v161, v37 row_newbcast:15 row_mask:0xf bank_mask:0xf
    v_dot2c_f32_bf16_dpp v30, v161, v38 row_newbcast:15 row_mask:0xf bank_mask:0xf
    v_dot2c_f32_bf16_dpp v31, v161, v39 row_newbcast:15 row_mask:0xf bank_mask:0xf
    v_dot2c_f32_bf16_dpp v32, v161, v40 row_newbcast:15 row_mask:0xf bank_mask:0xf
    v_dot2c_f32_bf16_dpp v33, v161, v41 row_newbcast:15 row_mask:0xf bank_mask:0xf
    v_dot2c_f32_bf16_dpp v34, v161, v42 row_newbcast:15 row_mask:0xf bank_mask:0xf
    v_dot2c_f32_bf16_dpp v35, v161, v43 row_newbcast:15 row_mask:0xf bank_mask:0xf
    s_nop 2
    v_permlane32_swap_b32 v12, v16
    v_permlane32_swap_b32 v13, v17
    v_permlane32_swap_b32 v14, v18
    v_permlane32_swap_b32 v15, v19
    v_add_f32 v12, v12, v16
    v_add_f32 v14, v14, v18
    v_add_f32 v13, v13, v17
    v_add_f32 v15, v15, v19
    s_nop 1
    v_permlane16_swap_b32 v12, v14
    v_permlane16_swap_b32 v13, v15
    v_add_f32 v12, v12, v14
    v_add_f32 v13, v13, v15
    s_nop 2
    v_permlane32_swap_b32 v28, v32
    v_permlane32_swap_b32 v29, v33
    v_permlane32_swap_b32 v30, v34
    v_permlane32_swap_b32 v31, v35
    v_add_f32 v28, v28, v32
    v_add_f32 v30, v30, v34
    v_add_f32 v29, v29, v33
    v_add_f32 v31, v31, v35
    s_nop 1
    v_permlane16_swap_b32 v28, v30
    v_permlane16_swap_b32 v29, v31
    v_add_f32 v28, v28, v30
    v_add_f32 v29, v29, v31
    ds_write_b64 v53, v[12:13] offset:0
    ds_write_b64 v53, v[28:29] offset:512
    v_mov_b32 v36, 0
    v_mov_b32 v37, 1
    s_waitcnt lgkmcnt(0)
    s_mov_b64 exec, 1
    ds_add_u32 v36, v37 offset:15360
    s_mov_b64 exec, -1
    s_cmp_eq_u32 s76, 1
    s_cbranch_scc1 Lpub
    s_cmp_lg_u32 s76, 0
    s_cbranch_scc1 Lcommon
    v_lshlrev_b32 v136, 16, v128
    v_and_b32 v137, 0xffff0000, v128
    v_lshlrev_b32 v144, 16, v132
    v_and_b32 v145, 0xffff0000, v132
    v_lshlrev_b32 v138, 16, v129
    v_and_b32 v139, 0xffff0000, v129
    v_lshlrev_b32 v146, 16, v133
    v_and_b32 v147, 0xffff0000, v133
    v_lshlrev_b32 v140, 16, v130
    v_and_b32 v141, 0xffff0000, v130
    v_lshlrev_b32 v148, 16, v134
    v_and_b32 v149, 0xffff0000, v134
    v_lshlrev_b32 v142, 16, v131
    v_and_b32 v143, 0xffff0000, v131
    v_lshlrev_b32 v150, 16, v135
    v_and_b32 v151, 0xffff0000, v135
    v_mul_f32 v136, v136, v144
    v_mul_f32 v137, v137, v145
    v_mul_f32 v138, v138, v146
    v_mul_f32 v139, v139, v147
    v_mul_f32 v140, v140, v148
    v_mul_f32 v141, v141, v149
    v_mul_f32 v142, v142, v150
    v_mul_f32 v143, v143, v151
    v_cvt_pk_bf16_f32 v136, 0, v136
    v_cvt_pk_bf16_f32 v137, 0, v137
    v_cvt_pk_bf16_f32 v138, 0, v138
    v_cvt_pk_bf16_f32 v139, 0, v139
    v_cvt_pk_bf16_f32 v140, 0, v140
    v_cvt_pk_bf16_f32 v141, 0, v141
    v_cvt_pk_bf16_f32 v142, 0, v142
    v_cvt_pk_bf16_f32 v143, 0, v143
    v_add_f32 v136, v136, v140
    v_add_f32 v137, v137, v141
    v_add_f32 v138, v138, v142
    v_add_f32 v139, v139, v143
    v_add_f32 v136, v136, v138
    v_add_f32 v137, v137, v139
    v_add_f32 v136, v136, v137
    s_nop 1
    v_add_f32_dpp v136, v136, v136 row_ror:8 row_mask:0xf bank_mask:0xf
    s_nop 1
    v_add_f32_dpp v136, v136, v136 row_ror:4 row_mask:0xf bank_mask:0xf
    s_nop 1
    v_add_f32_dpp v136, v136, v136 row_ror:2 row_mask:0xf bank_mask:0xf
    s_nop 1
    v_add_f32_dpp v136, v136, v136 row_ror:1 row_mask:0xf bank_mask:0xf
    v_mov_b32 v137, v136
    s_nop 1
    v_permlane32_swap_b32 v136, v137
    v_add_f32 v136, v136, v137
    v_mov_b32 v137, v136
    s_nop 1
    v_permlane16_swap_b32 v136, v137
    v_add_f32 v136, v136, v137
    v_cvt_pk_bf16_f32 v136, 0, v136
    v_mul_f32 v136, s85, v136
    v_exp_f32 v136, -v136
    s_nop 0
    v_add_f32 v136, 1.0, v136
    v_rcp_f32 v136, v136
    s_nop 0
    v_cvt_pk_bf16_f32 v136, 0, v136
    v_sub_f32 v137, 1.0, v136
    v_cvt_pk_bf16_f32 v137, 0, v137
    s_mov_b64 exec, 1
    ds_write_b64 v36, v[136:137] offset:15432
    s_mov_b64 exec, -1
    s_waitcnt lgkmcnt(0)
    s_branch Lcommon
Lpub:
    s_mov_b32 s81, 0x40000
Lfl0:
    v_readfirstlane_b32 s79, v46
    s_nop 0
    s_cmp_lg_u32 s79, 0
    s_cbranch_scc1 Lcn0
    s_mov_b64 exec, 1
    buffer_load_dword v46, v45, s[32:35], 0 offen sc1
    s_mov_b64 exec, -1
    s_waitcnt vmcnt(0)
    s_sub_u32 s81, s81, 1
    s_cbranch_scc0 Lfl0
Lcn0:
    ds_read_b32 v37, v36 offset:15360
    s_waitcnt lgkmcnt(0)
    v_readfirstlane_b32 s78, v37
    s_nop 0
    s_cmp_lt_u32 s78, 4
    s_cbranch_scc1 Lcn0
    ds_read_b64 v[160:161], v52 offset:0
    ds_read_b64 v[162:163], v52 offset:1024
    ds_read_b64 v[164:165], v52 offset:2048
    ds_read_b64 v[166:167], v52 offset:3072
    ds_read_b64 v[168:169], v52 offset:512
    ds_read_b64 v[170:171], v52 offset:1536
    ds_read_b64 v[172:173], v52 offset:2560
    ds_read_b64 v[174:175], v52 offset:3584
    s_lshl_b32 s78, s79, 1
    s_lshr_b32 s79, s79, 14
    v_not_b32 v60, v60
    v_not_b32 v61, v61
    v_not_b32 v62, v62
    v_not_b32 v63, v63
    v_bfi_b32 v60, 1, v60, s78
    v_bfi_b32 v61, 1, v61, s79
    v_bfi_b32 v62, 1, v62, s78
    v_bfi_b32 v63, 1, v63, s79
    s_mov_b32 s78, 0xffff
    s_waitcnt lgkmcnt(0)
    v_add_f32 v160, v160, v164
    v_add_f32 v161, v161, v165
    v_add_f32 v162, v162, v166
    v_add_f32 v163, v163, v167
    v_add_f32 v168, v168, v172
    v_add_f32 v169, v169, v173
    v_add_f32 v170, v170, v174
    v_add_f32 v171, v171, v175
    v_add_f32 v160, v160, v162
    v_add_f32 v161, v161, v163
    v_add_f32 v168, v168, v170
    v_add_f32 v169, v169, v171
    v_cvt_pk_bf16_f32 v36, 0, v160
    v_cvt_pk_bf16_f32 v37, 0, v161
    v_cvt_pk_bf16_f32 v38, 0, v168
    v_cvt_pk_bf16_f32 v39, 0, v169
    v_bfi_b32 v36, s78, v60, v36
    v_bfi_b32 v37, s78, v61, v37
    v_bfi_b32 v38, s78, v62, v38
    v_bfi_b32 v39, s78, v63, v39
    buffer_store_dwordx2 v[36:37], v58, s[24:27], 0 offen sc1
    buffer_store_dwordx2 v[38:39], v58, s[24:27], 0 offen offset:512 sc1
    s_branch Lcommon
Lcodeend:
.section .rodata,"a"
.p2align 6
.amdhsa_kernel gated_mix__gqa_block_cached__sliding_block_cached__decode_kernel
  .amdhsa_next_free_vgpr 256
  .amdhsa_next_free_sgpr 102
  .amdhsa_accum_offset 256
  .amdhsa_group_segment_fixed_size 0
  .amdhsa_kernarg_size 112
  .amdhsa_user_sgpr_count 2
  .amdhsa_user_sgpr_kernarg_segment_ptr 1
  .amdhsa_system_sgpr_workgroup_id_x 1
  .amdhsa_float_denorm_mode_32 3
.end_amdhsa_kernel
```
